```python
import torch

def _softmax(x, axis=-1):
    return torch.softmax(x, dim=axis)
def _gelu(x):
    return torch.nn.functional.gelu(x, approximate="tanh")
def _silu(x):
    return torch.nn.functional.silu(x)
def _sigmoid(x):
    return torch.sigmoid(x)
def _layernorm(x, axis=-1, eps=1e-5):
    m = x.mean(dim=axis, keepdim=True)
    v = x.var(dim=axis, keepdim=True, unbiased=False)
    return (x - m) / torch.sqrt(v + eps)
def _scatter_add(tgt, idx, src, axis=0):
    return tgt.clone().index_add_(axis, idx, src)
def _segment_sum(src, seg, n):
    out = torch.zeros((n,) + src.shape[1:], dtype=src.dtype)
    return out.index_add_(0, seg, src)
def _pad(x, pw):
    flat = tuple(v for pair in reversed(pw) for v in pair)
    return torch.nn.functional.pad(x, flat)

kernel_name = 'recurrent_scan__ssm_conv_s5__glu_gated_glu__prompt'

def setup_inputs():

    _w = (lambda a: (lambda t: t.to(torch.bfloat16) if t.is_floating_point() else t)(torch.as_tensor(a)))
    def _A_setup():
        B, S, D = 1, 2048, 448
        P = D
        Lambda_re = -0.5 * (lambda _x: torch.exp(torch.as_tensor(_x)))((lambda *s: torch.randn(*s, dtype=torch.bfloat16) * 0.2)(P))
        Lambda_im = (lambda *s: torch.randn(*s, dtype=torch.bfloat16) * 0.4)(P) * 1.0
        B_re = (lambda *s: torch.randn(*s, dtype=torch.bfloat16) * 0.2)(P, D) * (D ** -0.5)
        B_im = (lambda *s: torch.randn(*s, dtype=torch.bfloat16) * 0.2)(P, D) * (D ** -0.5)
        C_re = (lambda *s: torch.randn(*s, dtype=torch.bfloat16) * 0.2)(D, P) * (P ** -0.5)
        C_im = (lambda *s: torch.randn(*s, dtype=torch.bfloat16) * 0.2)(D, P) * (P ** -0.5)
        log_dt = (lambda *s: torch.randn(*s, dtype=torch.bfloat16) * 0.2)(P) * 0.3 - 2.0
        Dskip = (lambda *s: torch.randn(*s, dtype=torch.bfloat16) * 0.05)(D)
        return {
            "x": _w((lambda *s: torch.randn(*s, dtype=torch.bfloat16) * 0.05)(B, S, D)),
            "Lambda_re": _w(Lambda_re),
            "Lambda_im": _w(Lambda_im),
            "B_re": _w(B_re),
            "B_im": _w(B_im),
            "C_re": _w(C_re),
            "C_im": _w(C_im),
            "log_dt": _w(log_dt),
            "Dskip": _w(Dskip),
        }
    _A_in = _A_setup()

    def _B_setup():
        B, S, D, F = 1, 2048, 448, 1792
        return {
            "x": _w((lambda *s: torch.randn(*s, dtype=torch.bfloat16) * 0.05)(B, S, D)),
            "w_gate": _w((lambda *s: torch.randn(*s, dtype=torch.bfloat16) * 0.05)(D, F)),
            "w_up": _w((lambda *s: torch.randn(*s, dtype=torch.bfloat16) * 0.05)(D, F)),
            "w_down": _w((lambda *s: torch.randn(*s, dtype=torch.bfloat16) * 0.05)(F, D)),
        }
    _B_in = _B_setup()

    return {
        "A_x": _A_in["x"],
        "A_Lambda_re": _A_in["Lambda_re"],
        "A_Lambda_im": _A_in["Lambda_im"],
        "A_B_re": _A_in["B_re"],
        "A_B_im": _A_in["B_im"],
        "A_C_re": _A_in["C_re"],
        "A_C_im": _A_in["C_im"],
        "A_log_dt": _A_in["log_dt"],
        "A_Dskip": _A_in["Dskip"],
        "B_x": _B_in["x"],
        "B_w_gate": _B_in["w_gate"],
        "B_w_up": _B_in["w_up"],
        "B_w_down": _B_in["w_down"],
    }

def reference(A_x, A_Lambda_re, A_Lambda_im, A_B_re, A_B_im, A_C_re, A_C_im, A_log_dt, A_Dskip, B_x, B_w_gate, B_w_up, B_w_down):
    def _A_ref(x, Lambda_re, Lambda_im, B_re, B_im, C_re, C_im, log_dt, Dskip):
        Bsz, L, H = x.shape
        Lam = Lambda_re + 1j * Lambda_im
        Bmat = B_re + 1j * B_im
        Cmat = C_re + 1j * C_im
        dt = torch.exp(log_dt)
        Lam_bar = torch.exp(dt * Lam)
        B_bar = ((Lam_bar - 1.0) / Lam)[:, None] * Bmat
        Bu = torch.einsum("bld,pd->blp", x + 0j, B_bar)
        h = torch.zeros_like(Bu[:, 0, :])
        hs = []
        for t in range(L):
            h = Lam_bar[None, :] * h + Bu[:, t, :]
            hs.append(h)
        hseq = torch.stack(hs, 1)
        y = 2.0 * torch.einsum("blp,dp->bld", hseq, Cmat).real + x * Dskip[None, None, :]
        return y

    def _B_ref(x, w_gate, w_up, w_down):
        g = torch.einsum("bsd,df->bsf", x, w_gate)
        u = torch.einsum("bsd,df->bsf", x, w_up)
        h = _sigmoid(g) * u
        return torch.einsum("bsf,fd->bsd", h, w_down)

    x = A_x
    xn = _layernorm(x, axis=-1)
    s = _A_ref(xn, A_Lambda_re, A_Lambda_im, A_B_re, A_B_im, A_C_re, A_C_im, A_log_dt, A_Dskip)
    g = _silu(_B_ref(xn, B_w_gate, B_w_up, B_w_down))
    return x + s * g
```

```asm
; @launch grid=(256,1,1) block=(512,1,1) lds=163840
.amdgcn_target "amdgcn-amd-amdhsa--gfx950"
.text
.globl recurrent_scan__ssm_conv_s5__glu_gated_glu__prompt_kernel
.p2align 8
.type recurrent_scan__ssm_conv_s5__glu_gated_glu__prompt_kernel,@function
recurrent_scan__ssm_conv_s5__glu_gated_glu__prompt_kernel:
    s_cmp_ge_u32 s2, 256
    s_cbranch_scc1 L_end
    s_load_dwordx16 s[16:31], s[0:1], 0
    s_load_dwordx16 s[32:47], s[0:1], 64
    v_lshrrev_b32 v1, 6, v0
    v_and_b32 v0, 63, v0
    v_readfirstlane_b32 s76, v1
    s_nop 0
    s_and_b32 s77, s76, 3
    s_lshr_b32 s78, s76, 2
    s_cmp_ge_u32 s2, 32
    s_cbranch_scc1 L_cpf_1
    s_cmp_lg_u32 s76, 7
    s_cbranch_scc1 L_cpf_1
    s_getpc_b64 s[8:9]
L_pcref:
    s_sub_u32 s8, s8, L_pcref-recurrent_scan__ssm_conv_s5__glu_gated_glu__prompt_kernel
    s_subb_u32 s9, s9, 0
    s_mov_b32 s10, L_end-recurrent_scan__ssm_conv_s5__glu_gated_glu__prompt_kernel
    v_lshlrev_b32 v4, 7, v0
    v_mov_b32 v5, 0
    v_add_u32 v8, 24576, v4
    v_min_u32 v8, s10, v8
    v_mov_b32 v7, s9
    v_add_co_u32 v6, vcc, s8, v8
    s_nop 1
    v_addc_co_u32 v7, vcc, v7, v5, vcc
    global_load_dword v120, v[6:7], off
    v_add_u32 v8, 0, v4
    v_min_u32 v8, s10, v8
    v_mov_b32 v7, s9
    v_add_co_u32 v6, vcc, s8, v8
    s_nop 1
    v_addc_co_u32 v7, vcc, v7, v5, vcc
    global_load_dword v120, v[6:7], off
    v_add_u32 v8, 8192, v4
    v_min_u32 v8, s10, v8
    v_mov_b32 v7, s9
    v_add_co_u32 v6, vcc, s8, v8
    s_nop 1
    v_addc_co_u32 v7, vcc, v7, v5, vcc
    global_load_dword v120, v[6:7], off
    v_add_u32 v8, 16384, v4
    v_min_u32 v8, s10, v8
    v_mov_b32 v7, s9
    v_add_co_u32 v6, vcc, s8, v8
    s_nop 1
    v_addc_co_u32 v7, vcc, v7, v5, vcc
    global_load_dword v120, v[6:7], off
L_cpf_1:
    s_cmp_lt_u32 s2, 32
    s_cbranch_scc1 L_helper
    s_and_b32 s85, s2, 7
    s_sub_u32 s86, s2, 32
    s_lshr_b32 s86, s86, 3
    s_and_b32 s87, s86, 3
    s_lshr_b32 s84, s86, 2
    s_lshr_b32 s88, s85, 1
    s_lshl_b32 s88, s88, 2
    s_add_u32 s79, s88, s87
    s_and_b32 s88, s85, 1
    s_mul_i32 s88, s88, 7
    s_add_u32 s80, s88, s84
    s_lshl_b32 s88, s85, 2
    s_add_u32 s81, s88, s87
    s_lshl_b32 s85, s79, 7
    s_lshl_b32 s86, s76, 4
    s_add_u32 s85, s85, s86
    s_mul_i32 s91, s85, 896
    s_lshl_b32 s85, s80, 5
    s_lshl_b32 s86, s78, 4
    s_add_u32 s7, s85, s86
    s_and_b32 s86, s76, 1
    s_lshl_b32 s86, s86, 3
    s_add_u32 s85, s7, s86
    s_mul_i32 s92, s85, 896
    s_mul_i32 s85, s76, 28672
    s_lshl_b32 s86, s80, 8
    s_add_u32 s93, s85, s86
    s_mul_i32 s85, s77, 57344
    s_add_u32 s13, s85, s86
    s_lshl_b32 s4, s76, 11
    s_lshl_b32 s5, s76, 10
    s_lshl_b32 s6, s77, 12
    v_lshrrev_b32 v10, 3, v0
    v_and_b32 v11, 7, v0
    v_lshrrev_b32 v12, 4, v0
    v_mul_u32_u24 v13, 896, v10
    v_xor_b32 v14, v11, v12
    v_lshlrev_b32 v14, 4, v14
    v_add_u32 v64, v13, v14
    v_or_b32 v14, 4, v12
    v_xor_b32 v14, v11, v14
    v_lshlrev_b32 v14, 4, v14
    v_add_u32 v65, v13, v14
    v_add_u32 v65, 7168, v65
    s_and_b32 s85, s76, 1
    s_lshl_b32 s85, s85, 2
    v_or_b32 v14, s85, v12
    v_xor_b32 v14, v11, v14
    v_lshlrev_b32 v14, 4, v14
    v_add_u32 v66, v13, v14
    v_lshrrev_b32 v10, 3, v0
    v_and_b32 v11, 7, v0
    v_lshrrev_b32 v12, 4, v0
    v_mul_u32_u24 v13, 3584, v10
    v_and_b32 v14, 1, v11
    v_lshlrev_b32 v14, 4, v14
    v_add_u32 v13, v13, v14
    v_lshrrev_b32 v14, 1, v11
    v_and_b32 v15, 1, v12
    v_xor_b32 v1, v14, v15
    v_lshlrev_b32 v1, 5, v1
    v_add_u32 v4, v13, v1
    v_or_b32 v15, 2, v15
    v_xor_b32 v1, v14, v15
    v_lshlrev_b32 v1, 5, v1
    v_add_u32 v5, v13, v1
    v_and_b32 v1, 31, v0
    v_lshrrev_b32 v10, 5, v0
    v_lshrrev_b32 v12, 2, v1
    v_and_b32 v12, 1, v12
    v_lshlrev_b32 v11, 4, v12
    v_lshrrev_b32 v12, 3, v1
    v_lshlrev_b32 v12, 2, v12
    v_add_u32 v11, v11, v12
    v_and_b32 v12, 3, v1
    v_add_u32 v11, v11, v12
    s_lshl_b32 s85, s77, 5
    v_add_u32 v12, s85, v11
    v_lshlrev_b32 v12, 7, v12
    v_lshrrev_b32 v13, 1, v11
    v_and_b32 v13, 7, v13
    v_or_b32 v14, 0, v10
    v_xor_b32 v14, v14, v13
    v_lshlrev_b32 v14, 4, v14
    v_add_u32 v68, v12, v14
    v_or_b32 v14, 2, v10
    v_xor_b32 v14, v14, v13
    v_lshlrev_b32 v14, 4, v14
    v_add_u32 v69, v12, v14
    v_or_b32 v14, 4, v10
    v_xor_b32 v14, v14, v13
    v_lshlrev_b32 v14, 4, v14
    v_add_u32 v70, v12, v14
    v_or_b32 v14, 6, v10
    v_xor_b32 v14, v14, v13
    v_lshlrev_b32 v14, 4, v14
    v_add_u32 v71, v12, v14
    s_lshl_b32 s85, s78, 5
    v_add_u32 v12, s85, v1
    v_lshlrev_b32 v12, 7, v12
    v_add_u32 v12, 114688, v12
    v_lshrrev_b32 v13, 1, v1
    v_and_b32 v13, 7, v13
    v_or_b32 v14, 0, v10
    v_xor_b32 v14, v14, v13
    v_lshlrev_b32 v14, 4, v14
    v_add_u32 v72, v12, v14
    v_or_b32 v14, 2, v10
    v_xor_b32 v14, v14, v13
    v_lshlrev_b32 v14, 4, v14
    v_add_u32 v73, v12, v14
    v_or_b32 v14, 4, v10
    v_xor_b32 v14, v14, v13
    v_lshlrev_b32 v14, 4, v14
    v_add_u32 v74, v12, v14
    v_or_b32 v14, 6, v10
    v_xor_b32 v14, v14, v13
    v_lshlrev_b32 v14, 4, v14
    v_add_u32 v75, v12, v14
    v_lshrrev_b32 v1, 4, v0
    v_and_b32 v10, 1, v1
    v_lshrrev_b32 v11, 1, v1
    v_lshrrev_b32 v12, 2, v0
    v_and_b32 v12, 3, v12
    v_and_b32 v13, 3, v0
    v_lshlrev_b32 v14, 11, v11
    v_lshlrev_b32 v15, 10, v10
    v_add_u32 v14, v14, v15
    v_lshlrev_b32 v15, 7, v12
    v_add_u32 v14, v14, v15
    v_lshlrev_b32 v15, 3, v13
    v_add_u32 v14, v14, v15
    s_lshl_b32 s85, s78, 14
    v_add_u32 v14, s85, v14
    v_lshrrev_b32 v12, 1, v12
    v_lshlrev_b32 v10, 1, v10
    v_or_b32 v12, v12, v10
    v_xor_b32 v15, 0, v12
    v_lshlrev_b32 v15, 5, v15
    v_add_u32 v6, v14, v15
    v_xor_b32 v15, 1, v12
    v_lshlrev_b32 v15, 5, v15
    v_add_u32 v7, v14, v15
    v_xor_b32 v15, 2, v12
    v_lshlrev_b32 v15, 5, v15
    v_add_u32 v8, v14, v15
    v_xor_b32 v15, 3, v12
    v_lshlrev_b32 v15, 5, v15
    v_add_u32 v9, v14, v15
    v_and_b32 v10, 15, v0
    v_add_u32 v10, s7, v10
    v_lshlrev_b32 v10, 1, v10
    v_lshlrev_b32 v2, 4, v0
    v_mov_b32 v104, 0
    s_waitcnt lgkmcnt(0)
    s_mov_b32 s48, s16
    s_mov_b32 s49, s17
    s_mov_b32 s50, 1835008
    s_mov_b32 s51, 0x00020000
    s_lshr_b32 s85, s76, 1
    s_and_b32 s85, s85, 1
    s_cmp_eq_u32 s85, 0
    s_cselect_b32 s52, s22, s24
    s_cselect_b32 s53, s23, s25
    s_mov_b32 s54, 401408
    s_mov_b32 s55, 0x00020000
    s_add_u32 m0, s4, 0
    s_add_u32 s86, s91, 0
    buffer_load_dwordx4 v64, s[48:51], s86 offen lds
    s_add_u32 m0, s4, 1024
    s_add_u32 s86, s91, 0
    buffer_load_dwordx4 v65, s[48:51], s86 offen lds
    s_add_u32 m0, s5, 114688
    s_add_u32 s86, s92, 0
    buffer_load_dwordx4 v66, s[52:55], s86 offen lds
    s_add_u32 m0, s4, 16384
    s_add_u32 s86, s91, 128
    buffer_load_dwordx4 v64, s[48:51], s86 offen lds
    s_add_u32 m0, s4, 17408
    s_add_u32 s86, s91, 128
    buffer_load_dwordx4 v65, s[48:51], s86 offen lds
    s_add_u32 m0, s5, 122880
    s_add_u32 s86, s92, 128
    buffer_load_dwordx4 v66, s[52:55], s86 offen lds
    s_load_dwordx2 s[82:83], s[46:47], 0
    s_mov_b32 s64, s46
    s_mov_b32 s65, s47
    s_mov_b32 s66, 15204352
    s_mov_b32 s67, 0x00020000
    s_barrier
    s_add_u32 m0, s4, 32768
    s_add_u32 s86, s91, 256
    buffer_load_dwordx4 v64, s[48:51], s86 offen lds
    s_add_u32 m0, s4, 33792
    s_add_u32 s86, s91, 256
    buffer_load_dwordx4 v65, s[48:51], s86 offen lds
    s_add_u32 m0, s5, 131072
    s_add_u32 s86, s92, 256
    buffer_load_dwordx4 v66, s[52:55], s86 offen lds
    s_add_u32 m0, s4, 49152
    s_add_u32 s86, s91, 384
    buffer_load_dwordx4 v64, s[48:51], s86 offen lds
    s_add_u32 m0, s4, 50176
    s_add_u32 s86, s91, 384
    buffer_load_dwordx4 v65, s[48:51], s86 offen lds
    s_add_u32 m0, s5, 139264
    s_add_u32 s86, s92, 384
    buffer_load_dwordx4 v66, s[52:55], s86 offen lds
    global_load_ushort v76, v10, s[18:19]
    global_load_ushort v77, v10, s[20:21]
    global_load_ushort v78, v10, s[30:31]
    s_sub_u32 s85, s2, 32
    s_cmp_ge_u32 s85, 112
    s_cbranch_scc1 L_bfc_2
    s_cmp_eq_u32 s76, 7
    s_cbranch_scc1 L_bfe_3
    s_mov_b32 s68, s40
    s_mov_b32 s69, s41
    s_mov_b32 s70, 1605632
    s_mov_b32 s71, 0x00020000
    v_lshrrev_b32 v10, 3, v0
    v_and_b32 v11, 7, v0
    v_lshrrev_b32 v1, 4, v0
    v_and_b32 v1, 1, v1
    v_mul_u32_u24 v100, 896, v10
    v_lshrrev_b32 v10, 2, v11
    v_xor_b32 v10, v10, v1
    v_lshlrev_b32 v10, 6, v10
    v_add_u32 v100, v100, v10
    v_and_b32 v10, 3, v11
    v_lshlrev_b32 v10, 4, v10
    v_add_u32 v100, v100, v10
    s_mul_i32 s87, s85, 14336
    s_lshl_b32 s88, s76, 7
    s_add_u32 s87, s87, s88
    s_add_u32 m0, s4, 98304
    s_add_u32 s88, s87, 0
    buffer_load_dwordx4 v100, s[68:71], s88 offen lds
    s_add_u32 m0, s4, 99328
    s_add_u32 s88, s87, 7168
    buffer_load_dwordx4 v100, s[68:71], s88 offen lds
    s_branch L_bfe_3
L_bfc_2:
    s_and_b32 s86, s76, 1
    s_cmp_eq_u32 s86, 0
    s_cselect_b32 s68, s26, s28
    s_cselect_b32 s69, s27, s29
    s_mov_b32 s70, 401408
    s_mov_b32 s71, 0x00020000
    s_sub_u32 s85, s85, 112
    s_lshr_b32 s87, s85, 2
    s_and_b32 s88, s85, 3
    s_mul_i32 s89, s88, 14
    s_lshr_b32 s90, s76, 1
    s_lshl_b32 s90, s90, 2
    s_add_u32 s89, s89, s90
    v_lshrrev_b32 v10, 4, v0
    v_and_b32 v11, 15, v0
    v_mul_u32_u24 v100, 896, v11
    v_lshlrev_b32 v1, 4, v10
    v_add_u32 v100, v100, v1
    v_lshlrev_b32 v104, 11, v10
    v_lshlrev_b32 v1, 4, v11
    v_add_u32 v104, v104, v1
    s_mul_i32 s85, s87, 14336
    s_lshl_b32 s88, s89, 4
    s_add_u32 s85, s85, s88
    s_lshr_b32 s88, s87, 2
    s_mul_i32 s88, s88, 168
    s_add_u32 s88, s88, s89
    s_add_u32 s88, s88, 112
    s_lshl_b32 s14, s88, 11
    s_lshr_b32 s88, s87, 1
    s_and_b32 s88, s88, 1
    s_lshl_b32 s88, s88, 10
    s_add_u32 s14, s14, s88
    s_lshl_b32 s88, s86, 9
    s_add_u32 s14, s14, s88
    s_and_b32 s88, s87, 1
    s_lshl_b32 s88, s88, 8
    s_add_u32 s14, s14, s88
    s_add_u32 s14, s14, 1048576
    v_add_u32 v10, s90, v10
    v_cmp_gt_u32 vcc, 14, v10
    s_nop 0
    s_mov_b64 s[98:99], vcc
    s_mov_b64 s[96:97], exec
    s_mov_b64 exec, vcc
    buffer_load_dwordx4 v[96:99], v100, s[68:71], s85 offen
    s_mov_b64 exec, s[96:97]
    s_mov_b32 s15, s98
    s_mov_b32 s3, s99
L_bfe_3:
    s_nop 0
    s_mov_b32 s56, s36
    s_mov_b32 s57, s37
    s_mov_b32 s58, 1605632
    s_mov_b32 s59, 0x00020000
    s_mov_b32 s60, s38
    s_mov_b32 s61, s39
    s_mov_b32 s62, 1605632
    s_mov_b32 s63, 0x00020000
    s_waitcnt lgkmcnt(0)
    s_add_u32 s82, s82, 1
    s_waitcnt vmcnt(9)
    s_waitcnt lgkmcnt(0)
    s_barrier
    ds_read_b128 v[128:131], v68 offset:0
    ds_read_b128 v[16:19], v72 offset:0
    ds_read_b128 v[132:135], v69 offset:0
    ds_read_b128 v[20:23], v73 offset:0
    ds_read_b128 v[136:139], v70 offset:0
    ds_read_b128 v[24:27], v74 offset:0
    ds_read_b128 v[140:143], v71 offset:0
    ds_read_b128 v[28:31], v75 offset:0
    s_add_u32 m0, s4, 65536
    s_add_u32 s86, s91, 512
    buffer_load_dwordx4 v64, s[48:51], s86 offen lds
    s_waitcnt lgkmcnt(6)
    v_mfma_f32_32x32x16_bf16 v[48:63], v[128:131], v[16:19], 0
    s_add_u32 m0, s4, 66560
    s_add_u32 s86, s91, 512
    buffer_load_dwordx4 v65, s[48:51], s86 offen lds
    s_waitcnt lgkmcnt(4)
    v_mfma_f32_32x32x16_bf16 v[48:63], v[132:135], v[20:23], v[48:63]
    s_add_u32 m0, s5, 147456
    s_add_u32 s86, s92, 512
    buffer_load_dwordx4 v66, s[52:55], s86 offen lds
    s_waitcnt lgkmcnt(2)
    v_mfma_f32_32x32x16_bf16 v[48:63], v[136:139], v[24:27], v[48:63]
    s_add_u32 m0, s4, 81920
    s_add_u32 s86, s91, 640
    buffer_load_dwordx4 v64, s[48:51], s86 offen lds
    s_waitcnt lgkmcnt(0)
    v_mfma_f32_32x32x16_bf16 v[48:63], v[140:143], v[28:31], v[48:63]
    s_add_u32 m0, s4, 82944
    s_add_u32 s86, s91, 640
    buffer_load_dwordx4 v65, s[48:51], s86 offen lds
    ds_read_b128 v[144:147], v68 offset:16384
    ds_read_b128 v[32:35], v72 offset:8192
    ds_read_b128 v[148:151], v69 offset:16384
    ds_read_b128 v[36:39], v73 offset:8192
    ds_read_b128 v[152:155], v70 offset:16384
    ds_read_b128 v[40:43], v74 offset:8192
    ds_read_b128 v[156:159], v71 offset:16384
    ds_read_b128 v[44:47], v75 offset:8192
    s_add_u32 m0, s5, 155648
    s_add_u32 s86, s92, 640
    buffer_load_dwordx4 v66, s[52:55], s86 offen lds
    s_waitcnt lgkmcnt(6)
    v_mfma_f32_32x32x16_bf16 v[48:63], v[144:147], v[32:35], v[48:63]
    s_waitcnt lgkmcnt(4)
    v_mfma_f32_32x32x16_bf16 v[48:63], v[148:151], v[36:39], v[48:63]
    s_waitcnt lgkmcnt(2)
    v_mfma_f32_32x32x16_bf16 v[48:63], v[152:155], v[40:43], v[48:63]
    s_waitcnt lgkmcnt(0)
    v_mfma_f32_32x32x16_bf16 v[48:63], v[156:159], v[44:47], v[48:63]
    s_waitcnt vmcnt(9)
    s_waitcnt lgkmcnt(0)
    s_barrier
    s_waitcnt vmcnt(6)
    v_lshlrev_b32 v76, 16, v76
    v_lshlrev_b32 v77, 16, v77
    v_lshlrev_b32 v78, 16, v78
    v_mul_f32 v82, 0x3fb8aa3b, v78
    v_exp_f32 v82, v82
    s_nop 0
    v_cvt_pk_bf16_f32 v82, v82, v82
    v_and_b32 v82, 0xffff0000, v82
    v_mul_f32 v83, v82, v76
    v_mul_f32 v84, v82, v77
    v_mul_f32 v83, 0x3fb8aa3b, v83
    v_exp_f32 v83, v83
    v_mul_f32 v84, 0x3e22f983, v84
    v_cos_f32 v85, v84
    v_sin_f32 v86, v84
    v_mul_f32 v240, v83, v85
    v_mul_f32 v241, v83, v86
    v_add_f32 v87, -1.0, v240
    v_mul_f32 v88, v76, v76
    v_fmac_f32 v88, v77, v77
    v_rcp_f32 v88, v88
    v_mul_f32 v89, v87, v76
    v_fmac_f32 v89, v241, v77
    v_mul_f32 v90, v241, v76
    v_fma_f32 v90, -v87, v77, v90
    v_mul_f32 v88, 0xbfb17218, v88
    v_mul_f32 v250, v89, v88
    v_mul_f32 v251, v90, v88
    v_mul_f32 v91, v241, v241
    v_mul_f32 v93, v240, v241
    v_fma_f32 v92, v240, v240, -v91
    v_add_f32 v93, v93, v93
    v_mul_f32 v91, v93, v93
    v_mul_f32 v95, v92, v93
    v_fma_f32 v94, v92, v92, -v91
    v_add_f32 v95, v95, v95
    v_mul_f32 v91, v95, v95
    v_mul_f32 v243, v94, v95
    v_fma_f32 v242, v94, v94, -v91
    v_add_f32 v243, v243, v243
    v_mul_f32 v91, v243, v243
    v_mul_f32 v245, v242, v243
    v_fma_f32 v244, v242, v242, -v91
    v_add_f32 v245, v245, v245
    v_mul_f32 v91, v245, v245
    v_mul_f32 v247, v244, v245
    v_fma_f32 v246, v244, v244, -v91
    v_add_f32 v247, v247, v247
    v_mul_f32 v91, v247, v247
    v_mul_f32 v93, v246, v247
    v_fma_f32 v92, v246, v246, -v91
    v_add_f32 v93, v93, v93
    v_mul_f32 v91, v93, v93
    v_mul_f32 v249, v92, v93
    v_fma_f32 v248, v92, v92, -v91
    v_add_f32 v249, v249, v249
    s_waitcnt vmcnt(6)
    s_sub_u32 s85, s2, 32
    s_cmp_ge_u32 s85, 112
    s_cbranch_scc1 L_bfc_4
    s_cmp_eq_u32 s76, 7
    s_cbranch_scc1 L_bfe_5
    v_lshrrev_b32 v1, 4, v0
    v_and_b32 v10, 1, v1
    v_lshrrev_b32 v11, 1, v1
    v_lshlrev_b32 v101, 5, v10
    v_lshrrev_b32 v10, 2, v0
    v_and_b32 v10, 3, v10
    v_lshlrev_b32 v11, 2, v11
    v_add_u32 v11, v11, v10
    v_lshlrev_b32 v11, 7, v11
    v_add_u32 v101, v101, v11
    v_and_b32 v11, 3, v0
    v_lshlrev_b32 v11, 3, v11
    v_add_u32 v101, v101, v11
    v_add_u32 v101, s4, v101
    v_add_u32 v101, 98304, v101
    v_lshrrev_b32 v10, 1, v10
    v_lshlrev_b32 v11, 6, v10
    v_add_u32 v102, v101, v11
    v_xor_b32 v10, 1, v10
    v_lshlrev_b32 v11, 6, v10
    v_add_u32 v103, v101, v11
    ds_read_b64_tr_b16 v[80:81], v102 offset:0
    ds_read_b64_tr_b16 v[82:83], v102 offset:1024
    ds_read_b64_tr_b16 v[84:85], v103 offset:0
    ds_read_b64_tr_b16 v[86:87], v103 offset:1024
    s_mul_i32 s87, s76, 168
    s_add_u32 s87, s87, s85
    s_lshl_b32 s87, s87, 11
    s_add_u32 s87, s87, 1048576
    s_waitcnt lgkmcnt(0)
    buffer_store_dwordx4 v[80:83], v2, s[64:67], s87 offen offset:0 sc1
    buffer_store_dwordx4 v[84:87], v2, s[64:67], s87 offen offset:1024 sc1
    s_branch L_bfe_5
L_bfc_4:
    s_mov_b64 s[96:97], exec
    s_mov_b32 exec_lo, s15
    s_mov_b32 exec_hi, s3
    buffer_store_dwordx4 v[96:99], v104, s[64:67], s14 offen sc1
    s_mov_b64 exec, s[96:97]
L_bfe_5:
    s_nop 0
    s_barrier
    ds_read_b128 v[160:163], v68 offset:32768
    ds_read_b128 v[16:19], v72 offset:16384
    ds_read_b128 v[164:167], v69 offset:32768
    ds_read_b128 v[20:23], v73 offset:16384
    ds_read_b128 v[168:171], v70 offset:32768
    ds_read_b128 v[24:27], v74 offset:16384
    ds_read_b128 v[172:175], v71 offset:32768
    ds_read_b128 v[28:31], v75 offset:16384
    s_add_u32 m0, s4, 98304
    s_add_u32 s86, s91, 768
    buffer_load_dwordx4 v64, s[48:51], s86 offen lds
    s_waitcnt lgkmcnt(6)
    v_mfma_f32_32x32x16_bf16 v[48:63], v[160:163], v[16:19], v[48:63]
    s_add_u32 m0, s4, 99328
    s_add_u32 s86, s91, 768
    buffer_load_dwordx4 v65, s[48:51], s86 offen lds
    s_waitcnt lgkmcnt(4)
    v_mfma_f32_32x32x16_bf16 v[48:63], v[164:167], v[20:23], v[48:63]
    s_add_u32 m0, s5, 114688
    s_add_u32 s86, s92, 768
    buffer_load_dwordx4 v66, s[52:55], s86 offen lds
    s_waitcnt lgkmcnt(2)
    v_mfma_f32_32x32x16_bf16 v[48:63], v[168:171], v[24:27], v[48:63]
    s_add_u32 m0, s4, 0
    s_add_u32 s86, s93, 0
    buffer_load_dwordx4 v4, s[56:59], s86 offen lds
    s_waitcnt lgkmcnt(0)
    v_mfma_f32_32x32x16_bf16 v[48:63], v[172:175], v[28:31], v[48:63]
    s_add_u32 m0, s4, 1024
    s_add_u32 s86, s93, 0
    buffer_load_dwordx4 v5, s[60:63], s86 offen lds
    ds_read_b128 v[176:179], v68 offset:49152
    ds_read_b128 v[32:35], v72 offset:24576
    ds_read_b128 v[180:183], v69 offset:49152
    ds_read_b128 v[36:39], v73 offset:24576
    ds_read_b128 v[184:187], v70 offset:49152
    ds_read_b128 v[40:43], v74 offset:24576
    ds_read_b128 v[188:191], v71 offset:49152
    ds_read_b128 v[44:47], v75 offset:24576
    s_add_u32 m0, s4, 16384
    s_add_u32 s86, s93, 128
    buffer_load_dwordx4 v4, s[56:59], s86 offen lds
    s_waitcnt lgkmcnt(6)
    v_mfma_f32_32x32x16_bf16 v[48:63], v[176:179], v[32:35], v[48:63]
    s_add_u32 m0, s4, 17408
    s_add_u32 s86, s93, 128
    buffer_load_dwordx4 v5, s[60:63], s86 offen lds
    s_waitcnt lgkmcnt(4)
    v_mfma_f32_32x32x16_bf16 v[48:63], v[180:183], v[36:39], v[48:63]
    s_waitcnt lgkmcnt(2)
    v_mfma_f32_32x32x16_bf16 v[48:63], v[184:187], v[40:43], v[48:63]
    s_waitcnt lgkmcnt(0)
    v_mfma_f32_32x32x16_bf16 v[48:63], v[188:191], v[44:47], v[48:63]
    v_add_u32 v68, 0x10000, v68
    v_add_u32 v69, 0x10000, v69
    v_add_u32 v70, 0x10000, v70
    v_add_u32 v71, 0x10000, v71
    s_waitcnt vmcnt(7)
    s_waitcnt lgkmcnt(0)
    s_barrier
    ds_read_b128 v[192:195], v68 offset:0
    ds_read_b128 v[16:19], v72 offset:32768
    ds_read_b128 v[196:199], v69 offset:0
    ds_read_b128 v[20:23], v73 offset:32768
    ds_read_b128 v[200:203], v70 offset:0
    ds_read_b128 v[24:27], v74 offset:32768
    ds_read_b128 v[204:207], v71 offset:0
    ds_read_b128 v[28:31], v75 offset:32768
    s_add_u32 m0, s4, 32768
    s_add_u32 s86, s93, 229376
    buffer_load_dwordx4 v4, s[56:59], s86 offen lds
    s_waitcnt lgkmcnt(6)
    v_mfma_f32_32x32x16_bf16 v[48:63], v[192:195], v[16:19], v[48:63]
    s_add_u32 m0, s4, 33792
    s_add_u32 s86, s93, 229376
    buffer_load_dwordx4 v5, s[60:63], s86 offen lds
    s_waitcnt lgkmcnt(4)
    v_mfma_f32_32x32x16_bf16 v[48:63], v[196:199], v[20:23], v[48:63]
    s_add_u32 m0, s4, 49152
    s_add_u32 s86, s93, 229504
    buffer_load_dwordx4 v4, s[56:59], s86 offen lds
    s_waitcnt lgkmcnt(2)
    v_mfma_f32_32x32x16_bf16 v[48:63], v[200:203], v[24:27], v[48:63]
    s_add_u32 m0, s4, 50176
    s_add_u32 s86, s93, 229504
    buffer_load_dwordx4 v5, s[60:63], s86 offen lds
    s_waitcnt lgkmcnt(0)
    v_mfma_f32_32x32x16_bf16 v[48:63], v[204:207], v[28:31], v[48:63]
    s_cmp_lg_u32 s76, 4
    s_cbranch_scc1 L_pa_6
    s_lshl_b32 s85, s79, 11
    s_add_u32 s85, s85, 196608
    s_mov_b32 m0, 122880
    s_add_u32 s87, s85, 0
    buffer_load_dwordx4 v2, s[64:67], s87 offen sc1 lds
    s_mov_b32 m0, 123904
    s_add_u32 s87, s85, 1024
    buffer_load_dwordx4 v2, s[64:67], s87 offen sc1 lds
    s_lshl_b32 s85, s80, 10
    s_add_u32 s85, s85, 278528
    s_mov_b32 m0, 124928
    s_nop 0
    buffer_load_dwordx4 v2, s[64:67], s85 offen sc1 lds
L_pa_6:
    ds_read_b128 v[208:211], v68 offset:16384
    ds_read_b128 v[32:35], v72 offset:40960
    ds_read_b128 v[212:215], v69 offset:16384
    ds_read_b128 v[36:39], v73 offset:40960
    ds_read_b128 v[216:219], v70 offset:16384
    ds_read_b128 v[40:43], v74 offset:40960
    ds_read_b128 v[220:223], v71 offset:16384
    ds_read_b128 v[44:47], v75 offset:40960
    s_waitcnt lgkmcnt(6)
    v_mfma_f32_32x32x16_bf16 v[48:63], v[208:211], v[32:35], v[48:63]
    s_waitcnt lgkmcnt(4)
    v_mfma_f32_32x32x16_bf16 v[48:63], v[212:215], v[36:39], v[48:63]
    s_waitcnt lgkmcnt(2)
    v_mfma_f32_32x32x16_bf16 v[48:63], v[216:219], v[40:43], v[48:63]
    s_waitcnt lgkmcnt(0)
    v_mfma_f32_32x32x16_bf16 v[48:63], v[220:223], v[44:47], v[48:63]
    s_waitcnt vmcnt(8)
    s_waitcnt lgkmcnt(0)
    s_barrier
    s_cmp_lg_u32 s76, 0
    s_cbranch_scc1 L_f3_7
    s_sub_u32 s85, s2, 32
    s_lshl_b32 s85, s85, 3
    s_add_u32 s85, s85, 8192
    v_mov_b32 v1, 0
    v_mov_b32 v10, s82
    v_mov_b32 v11, s83
    s_mov_b64 s[96:97], exec
    s_mov_b64 exec, 1
    buffer_store_dwordx2 v[10:11], v1, s[64:67], s85 offen sc1
    s_mov_b64 exec, s[96:97]
L_f3_7:
    s_cmp_lg_u32 s76, 4
    s_cbranch_scc1 L_pk_8
    s_waitcnt vmcnt(0)
    s_mov_b32 s94, 0
    s_and_b32 s88, s83, 0xffff
    v_add_u32 v10, 122888, v2
L_pkc_9:
    ds_read_b64 v[42:43], v10
    ds_read_b64 v[44:45], v10 offset:1024
    ds_read_b64 v[46:47], v10 offset:2048
    s_waitcnt lgkmcnt(0)
    v_and_b32 v42, 0xffff, v42
    v_xor_b32 v42, s88, v42
    v_xor_b32 v43, s82, v43
    v_or_b32 v42, v42, v43
    v_and_b32 v44, 0xffff, v44
    v_xor_b32 v44, s88, v44
    v_xor_b32 v45, s82, v45
    v_or_b32 v44, v44, v45
    v_and_b32 v46, 0xffff, v46
    v_xor_b32 v46, s88, v46
    v_xor_b32 v47, s82, v47
    v_or_b32 v46, v46, v47
    v_or3_b32 v42, v42, v44, v46
    v_cmp_ne_u32 vcc, 0, v42
    s_cbranch_vccz L_pko_10
    s_sleep 1
    s_lshl_b32 s85, s79, 11
    s_add_u32 s85, s85, 196608
    s_mov_b32 m0, 122880
    s_add_u32 s87, s85, 0
    buffer_load_dwordx4 v2, s[64:67], s87 offen sc1 lds
    s_mov_b32 m0, 123904
    s_add_u32 s87, s85, 1024
    buffer_load_dwordx4 v2, s[64:67], s87 offen sc1 lds
    s_lshl_b32 s85, s80, 10
    s_add_u32 s85, s85, 278528
    s_mov_b32 m0, 124928
    s_nop 0
    buffer_load_dwordx4 v2, s[64:67], s85 offen sc1 lds
    s_waitcnt vmcnt(0)
    s_add_u32 s94, s94, 1
    s_cmp_lt_u32 s94, 50000
    s_cbranch_scc1 L_pkc_9
L_pko_10:
    v_mov_b32 v10, 128000
    v_mov_b32 v11, 0
    ds_write_b32 v10, v11
L_pk_8:
    ds_read_b128 v[224:227], v68 offset:32768
    ds_read_b128 v[16:19], v72 offset:0
    ds_read_b128 v[228:231], v69 offset:32768
    ds_read_b128 v[20:23], v73 offset:0
    ds_read_b128 v[232:235], v70 offset:32768
    ds_read_b128 v[24:27], v74 offset:0
    ds_read_b128 v[236:239], v71 offset:32768
    ds_read_b128 v[28:31], v75 offset:0
    s_add_u32 m0, s4, 65536
    s_add_u32 s86, s93, 458752
    buffer_load_dwordx4 v4, s[56:59], s86 offen lds
    s_waitcnt lgkmcnt(6)
    v_mfma_f32_32x32x16_bf16 v[48:63], v[224:227], v[16:19], v[48:63]
    s_add_u32 m0, s4, 66560
    s_add_u32 s86, s93, 458752
    buffer_load_dwordx4 v5, s[60:63], s86 offen lds
    s_waitcnt lgkmcnt(4)
    v_mfma_f32_32x32x16_bf16 v[48:63], v[228:231], v[20:23], v[48:63]
    s_add_u32 m0, s4, 81920
    s_add_u32 s86, s93, 458880
    buffer_load_dwordx4 v4, s[56:59], s86 offen lds
    s_waitcnt lgkmcnt(2)
    v_mfma_f32_32x32x16_bf16 v[48:63], v[232:235], v[24:27], v[48:63]
    s_add_u32 m0, s4, 82944
    s_add_u32 s86, s93, 458880
    buffer_load_dwordx4 v5, s[60:63], s86 offen lds
    s_waitcnt lgkmcnt(0)
    v_mfma_f32_32x32x16_bf16 v[48:63], v[236:239], v[28:31], v[48:63]
    s_add_u32 m0, s4, 131072
    s_add_u32 s86, s93, 688128
    buffer_load_dwordx4 v4, s[56:59], s86 offen lds
    s_add_u32 m0, s4, 132096
    s_add_u32 s86, s93, 688128
    buffer_load_dwordx4 v5, s[60:63], s86 offen lds
    s_add_u32 m0, s4, 147456
    s_add_u32 s86, s93, 688256
    buffer_load_dwordx4 v4, s[56:59], s86 offen lds
    s_add_u32 m0, s4, 148480
    s_add_u32 s86, s93, 688256
    buffer_load_dwordx4 v5, s[60:63], s86 offen lds
    s_waitcnt vmcnt(8)
    s_waitcnt lgkmcnt(0)
    s_barrier
    ds_read_b64_tr_b16 v[16:17], v6 offset:0
    ds_read_b64_tr_b16 v[18:19], v6 offset:512
    ds_read_b64_tr_b16 v[20:21], v7 offset:0
    ds_read_b64_tr_b16 v[22:23], v7 offset:512
    ds_read_b64_tr_b16 v[24:25], v8 offset:0
    ds_read_b64_tr_b16 v[26:27], v8 offset:512
    s_waitcnt lgkmcnt(4)
    v_mfma_f32_32x32x16_bf16 v[64:79], v[16:19], v[128:131], 0
    ds_read_b64_tr_b16 v[28:29], v9 offset:0
    ds_read_b64_tr_b16 v[30:31], v9 offset:512
    v_lshrrev_b32 v10, 4, v0
    v_lshlrev_b32 v10, 7, v10
    s_lshl_b32 s85, s77, 9
    v_add_u32 v10, s85, v10
    v_add_u32 v10, 122880, v10
    ds_read_b64 v[32:33], v10 offset:0
    s_waitcnt lgkmcnt(4)
    v_mfma_f32_32x32x16_bf16 v[80:95], v[20:23], v[128:131], 0
    ds_read_b64_tr_b16 v[16:17], v6 offset:4096
    ds_read_b64_tr_b16 v[18:19], v6 offset:4608
    ds_read_b64 v[34:35], v10 offset:16
    ds_read_b64 v[36:37], v10 offset:32
    ds_read_b64 v[38:39], v10 offset:48
    v_and_b32 v11, 15, v0
    v_lshlrev_b32 v11, 4, v11
    s_lshl_b32 s85, s78, 9
    s_waitcnt lgkmcnt(4)
    v_mfma_f32_32x32x16_bf16 v[96:111], v[24:27], v[128:131], 0
    ds_read_b64_tr_b16 v[20:21], v7 offset:4096
    ds_read_b64_tr_b16 v[22:23], v7 offset:4608
    v_add_u32 v11, s85, v11
    v_add_u32 v11, 124928, v11
    ds_read_b32 v40, v11
    ds_read_b32 v41, v11 offset:256
    v_and_b32 v1, 31, v0
    v_lshrrev_b32 v42, 2, v1
    s_waitcnt lgkmcnt(4)
    v_mfma_f32_32x32x16_bf16 v[112:127], v[28:31], v[128:131], 0
    ds_read_b64_tr_b16 v[24:25], v8 offset:4096
    ds_read_b64_tr_b16 v[26:27], v8 offset:4608
    v_and_b32 v42, 1, v42
    v_lshlrev_b32 v11, 4, v42
    v_lshrrev_b32 v42, 3, v1
    v_lshlrev_b32 v42, 2, v42
    v_add_u32 v11, v11, v42
    v_and_b32 v42, 3, v1
    s_waitcnt lgkmcnt(4)
    v_mfma_f32_32x32x16_bf16 v[64:79], v[16:19], v[132:135], v[64:79]
    ds_read_b64_tr_b16 v[28:29], v9 offset:4096
    ds_read_b64_tr_b16 v[30:31], v9 offset:4608
    v_add_u32 v11, v11, v42
    s_lshl_b32 s85, s77, 5
    v_add_u32 v11, s85, v11
    v_lshlrev_b32 v11, 4, v11
    v_add_u32 v11, 122880, v11
    ds_read_b128 v[12:15], v11
    s_waitcnt lgkmcnt(4)
    v_mfma_f32_32x32x16_bf16 v[80:95], v[20:23], v[132:135], v[80:95]
    ds_read_b64_tr_b16 v[16:17], v6 offset:8192
    ds_read_b64_tr_b16 v[18:19], v6 offset:8704
    v_permlane16_swap_b32 v48, v56
    v_permlane16_swap_b32 v49, v57
    v_permlane16_swap_b32 v50, v58
    v_permlane16_swap_b32 v51, v59
    v_permlane16_swap_b32 v52, v60
    v_permlane16_swap_b32 v53, v61
    s_waitcnt lgkmcnt(4)
    v_mfma_f32_32x32x16_bf16 v[96:111], v[24:27], v[132:135], v[96:111]
    ds_read_b64_tr_b16 v[20:21], v7 offset:8192
    ds_read_b64_tr_b16 v[22:23], v7 offset:8704
    v_permlane16_swap_b32 v54, v62
    v_permlane16_swap_b32 v55, v63
    s_waitcnt lgkmcnt(4)
    v_mfma_f32_32x32x16_bf16 v[112:127], v[28:31], v[132:135], v[112:127]
    ds_read_b64_tr_b16 v[24:25], v8 offset:8192
    ds_read_b64_tr_b16 v[26:27], v8 offset:8704
    s_waitcnt lgkmcnt(4)
    v_mfma_f32_32x32x16_bf16 v[64:79], v[16:19], v[136:139], v[64:79]
    ds_read_b64_tr_b16 v[28:29], v9 offset:8192
    ds_read_b64_tr_b16 v[30:31], v9 offset:8704
    s_waitcnt lgkmcnt(4)
    v_mfma_f32_32x32x16_bf16 v[80:95], v[20:23], v[136:139], v[80:95]
    ds_read_b64_tr_b16 v[16:17], v6 offset:12288
    ds_read_b64_tr_b16 v[18:19], v6 offset:12800
    v_and_b32 v14, 0xffff0000, v14
    v_fma_f32 v48, v32, v40, v48
    v_fma_f32 v56, v32, v41, v56
    v_fma_f32 v49, v34, v40, v49
    v_fma_f32 v57, v34, v41, v57
    v_fma_f32 v50, v36, v40, v50
    s_waitcnt lgkmcnt(4)
    v_mfma_f32_32x32x16_bf16 v[96:111], v[24:27], v[136:139], v[96:111]
    ds_read_b64_tr_b16 v[20:21], v7 offset:12288
    ds_read_b64_tr_b16 v[22:23], v7 offset:12800
    v_fma_f32 v58, v36, v41, v58
    v_fma_f32 v51, v38, v40, v51
    v_fma_f32 v59, v38, v41, v59
    v_mul_f32 v48, v33, v48
    v_mul_f32 v56, v33, v56
    v_mul_f32 v49, v35, v49
    s_waitcnt lgkmcnt(4)
    v_mfma_f32_32x32x16_bf16 v[112:127], v[28:31], v[136:139], v[112:127]
    ds_read_b64_tr_b16 v[24:25], v8 offset:12288
    ds_read_b64_tr_b16 v[26:27], v8 offset:12800
    v_mul_f32 v57, v35, v57
    v_mul_f32 v50, v37, v50
    v_mul_f32 v58, v37, v58
    v_mul_f32 v51, v39, v51
    v_mul_f32 v59, v39, v59
    ds_read_b64 v[32:33], v10 offset:64
    s_waitcnt lgkmcnt(4)
    v_mfma_f32_32x32x16_bf16 v[64:79], v[16:19], v[140:143], v[64:79]
    ds_read_b64_tr_b16 v[28:29], v9 offset:12288
    ds_read_b64_tr_b16 v[30:31], v9 offset:12800
    ds_read_b64 v[34:35], v10 offset:80
    ds_read_b64 v[36:37], v10 offset:96
    ds_read_b64 v[38:39], v10 offset:112
    v_fma_f32 v42, v240, v48, v49
    v_fma_f32 v43, v240, v56, v57
    v_fma_f32 v42, -v241, v56, v42
    s_waitcnt lgkmcnt(4)
    v_mfma_f32_32x32x16_bf16 v[80:95], v[20:23], v[140:143], v[80:95]
    ds_read_b64_tr_b16 v[16:17], v6 offset:32768
    ds_read_b64_tr_b16 v[18:19], v6 offset:33280
    v_fma_f32 v43, v241, v48, v43
    v_fma_f32 v44, v240, v42, v50
    v_fma_f32 v45, v240, v43, v58
    v_fma_f32 v44, -v241, v43, v44
    v_fma_f32 v45, v241, v42, v45
    v_fma_f32 v42, v240, v44, v51
    s_waitcnt lgkmcnt(4)
    v_mfma_f32_32x32x16_bf16 v[96:111], v[24:27], v[140:143], v[96:111]
    ds_read_b64_tr_b16 v[20:21], v7 offset:32768
    ds_read_b64_tr_b16 v[22:23], v7 offset:33280
    v_fma_f32 v43, v240, v45, v59
    v_fma_f32 v42, -v241, v45, v42
    v_fma_f32 v43, v241, v44, v43
    s_waitcnt lgkmcnt(4)
    v_mfma_f32_32x32x16_bf16 v[112:127], v[28:31], v[140:143], v[112:127]
    ds_read_b64_tr_b16 v[24:25], v8 offset:32768
    ds_read_b64_tr_b16 v[26:27], v8 offset:33280
    s_waitcnt lgkmcnt(4)
    v_mfma_f32_32x32x16_bf16 v[64:79], v[16:19], v[144:147], v[64:79]
    ds_read_b64_tr_b16 v[28:29], v9 offset:32768
    ds_read_b64_tr_b16 v[30:31], v9 offset:33280
    s_waitcnt lgkmcnt(4)
    v_mfma_f32_32x32x16_bf16 v[80:95], v[20:23], v[144:147], v[80:95]
    ds_read_b64_tr_b16 v[16:17], v6 offset:36864
    ds_read_b64_tr_b16 v[18:19], v6 offset:37376
    v_fma_f32 v52, v32, v40, v52
    v_fma_f32 v60, v32, v41, v60
    v_fma_f32 v53, v34, v40, v53
    v_fma_f32 v61, v34, v41, v61
    v_fma_f32 v54, v36, v40, v54
    v_fma_f32 v62, v36, v41, v62
    s_waitcnt lgkmcnt(4)
    v_mfma_f32_32x32x16_bf16 v[96:111], v[24:27], v[144:147], v[96:111]
    ds_read_b64_tr_b16 v[20:21], v7 offset:36864
    ds_read_b64_tr_b16 v[22:23], v7 offset:37376
    v_fma_f32 v55, v38, v40, v55
    v_fma_f32 v63, v38, v41, v63
    v_mul_f32 v52, v33, v52
    v_mul_f32 v60, v33, v60
    v_mul_f32 v53, v35, v53
    v_mul_f32 v61, v35, v61
    s_waitcnt lgkmcnt(4)
    v_mfma_f32_32x32x16_bf16 v[112:127], v[28:31], v[144:147], v[112:127]
    ds_read_b64_tr_b16 v[24:25], v8 offset:36864
    ds_read_b64_tr_b16 v[26:27], v8 offset:37376
    v_mul_f32 v54, v37, v54
    v_mul_f32 v62, v37, v62
    v_mul_f32 v55, v39, v55
    v_mul_f32 v63, v39, v63
    v_fma_f32 v44, v240, v42, v52
    v_fma_f32 v45, v240, v43, v60
    s_waitcnt lgkmcnt(4)
    v_mfma_f32_32x32x16_bf16 v[64:79], v[16:19], v[148:151], v[64:79]
    ds_read_b64_tr_b16 v[28:29], v9 offset:36864
    ds_read_b64_tr_b16 v[30:31], v9 offset:37376
    v_fma_f32 v44, -v241, v43, v44
    v_fma_f32 v45, v241, v42, v45
    v_fma_f32 v42, v240, v44, v53
    v_fma_f32 v43, v240, v45, v61
    v_fma_f32 v42, -v241, v45, v42
    v_fma_f32 v43, v241, v44, v43
    s_waitcnt lgkmcnt(4)
    v_mfma_f32_32x32x16_bf16 v[80:95], v[20:23], v[148:151], v[80:95]
    ds_read_b64_tr_b16 v[16:17], v6 offset:40960
    ds_read_b64_tr_b16 v[18:19], v6 offset:41472
    v_fma_f32 v44, v240, v42, v54
    v_fma_f32 v45, v240, v43, v62
    v_fma_f32 v44, -v241, v43, v44
    v_fma_f32 v45, v241, v42, v45
    v_fma_f32 v42, v240, v44, v55
    v_fma_f32 v43, v240, v45, v63
    s_waitcnt lgkmcnt(4)
    v_mfma_f32_32x32x16_bf16 v[96:111], v[24:27], v[148:151], v[96:111]
    ds_read_b64_tr_b16 v[20:21], v7 offset:40960
    ds_read_b64_tr_b16 v[22:23], v7 offset:41472
    v_fma_f32 v42, -v241, v45, v42
    v_fma_f32 v43, v241, v44, v43
    v_mov_b32 v32, v42
    v_mov_b32 v33, v43
    v_mov_b32 v34, v42
    v_mov_b32 v35, v43
    s_waitcnt lgkmcnt(4)
    v_mfma_f32_32x32x16_bf16 v[112:127], v[28:31], v[148:151], v[112:127]
    ds_read_b64_tr_b16 v[24:25], v8 offset:40960
    ds_read_b64_tr_b16 v[26:27], v8 offset:41472
    v_permlane16_swap_b32 v32, v34
    v_permlane16_swap_b32 v33, v35
    v_fma_f32 v36, v242, v32, v34
    v_fma_f32 v37, v242, v33, v35
    v_fma_f32 v36, -v243, v33, v36
    v_fma_f32 v37, v243, v32, v37
    s_waitcnt lgkmcnt(4)
    v_mfma_f32_32x32x16_bf16 v[64:79], v[16:19], v[152:155], v[64:79]
    ds_read_b64_tr_b16 v[28:29], v9 offset:40960
    ds_read_b64_tr_b16 v[30:31], v9 offset:41472
    v_mov_b32 v38, v36
    v_mov_b32 v39, v37
    v_mov_b32 v40, v36
    v_mov_b32 v41, v37
    s_nop 0
    v_permlane32_swap_b32 v38, v40
    v_permlane32_swap_b32 v39, v41
    s_waitcnt lgkmcnt(4)
    v_mfma_f32_32x32x16_bf16 v[80:95], v[20:23], v[152:155], v[80:95]
    ds_read_b64_tr_b16 v[16:17], v6 offset:45056
    ds_read_b64_tr_b16 v[18:19], v6 offset:45568
    v_fma_f32 v46, v244, v38, v40
    v_fma_f32 v47, v244, v39, v41
    v_fma_f32 v46, -v245, v39, v46
    v_fma_f32 v47, v245, v38, v47
    v_fma_f32 v34, v242, v38, v32
    v_fma_f32 v35, v242, v39, v33
    s_waitcnt lgkmcnt(4)
    v_mfma_f32_32x32x16_bf16 v[96:111], v[24:27], v[152:155], v[96:111]
    ds_read_b64_tr_b16 v[20:21], v7 offset:45056
    ds_read_b64_tr_b16 v[22:23], v7 offset:45568
    v_fma_f32 v34, -v243, v39, v34
    v_fma_f32 v35, v243, v38, v35
    v_mul_f32 v44, v242, v244
    v_mul_f32 v45, v242, v245
    v_fma_f32 v44, -v243, v245, v44
    v_fma_f32 v45, v243, v244, v45
    s_waitcnt lgkmcnt(4)
    v_mfma_f32_32x32x16_bf16 v[112:127], v[28:31], v[152:155], v[112:127]
    ds_read_b64_tr_b16 v[24:25], v8 offset:45056
    ds_read_b64_tr_b16 v[26:27], v8 offset:45568
    v_and_b32 v10, 15, v0
    v_lshlrev_b32 v10, 3, v10
    s_lshl_b32 s85, s76, 7
    v_add_u32 v10, s85, v10
    v_add_u32 v10, 126976, v10
    ds_write_b64 v10, v[46:47]
    s_waitcnt lgkmcnt(4)
    v_mfma_f32_32x32x16_bf16 v[64:79], v[16:19], v[156:159], v[64:79]
    ds_read_b64_tr_b16 v[28:29], v9 offset:45056
    ds_read_b64_tr_b16 v[30:31], v9 offset:45568
    v_lshrrev_b32 v10, 4, v0
    v_cmp_eq_u32 s[96:97], 1, v10
    v_cmp_eq_u32 s[98:99], 2, v10
    v_cmp_eq_u32 vcc, 3, v10
    v_cndmask_b32 v252, 0, v32, s[96:97]
    v_cndmask_b32 v252, v252, v38, s[98:99]
    v_cndmask_b32 v252, v252, v34, vcc
    v_cndmask_b32 v253, 0, v33, s[96:97]
    v_cndmask_b32 v253, v253, v39, s[98:99]
    v_cndmask_b32 v253, v253, v35, vcc
    v_mov_b32 v254, 1.0
    v_mov_b32 v255, 0
    v_cndmask_b32 v254, v254, v242, s[96:97]
    v_cndmask_b32 v254, v254, v244, s[98:99]
    v_cndmask_b32 v254, v254, v44, vcc
    v_cndmask_b32 v255, v255, v243, s[96:97]
    v_cndmask_b32 v255, v255, v245, s[98:99]
    v_cndmask_b32 v255, v255, v45, vcc
    s_waitcnt lgkmcnt(4)
    v_mfma_f32_32x32x16_bf16 v[80:95], v[20:23], v[156:159], v[80:95]
    v_min_u32 v138, 55, v0
    v_lshlrev_b32 v138, 4, v138
    v_add_u32 v138, 8192, v138
    buffer_load_dwordx4 v[140:143], v138, s[64:67], 0 offen sc1
    buffer_load_dwordx4 v[144:147], v138, s[64:67], 0 offen offset:896 sc1
    s_waitcnt lgkmcnt(2)
    v_mfma_f32_32x32x16_bf16 v[96:111], v[24:27], v[156:159], v[96:111]
    s_waitcnt lgkmcnt(0)
    v_mfma_f32_32x32x16_bf16 v[112:127], v[28:31], v[156:159], v[112:127]
    s_waitcnt vmcnt(2)
    s_waitcnt lgkmcnt(0)
    s_barrier
    s_waitcnt vmcnt(0)
    s_mov_b32 s94, 0
L_fl_11:
    v_xor_b32 v140, s82, v140
    v_xor_b32 v141, s83, v141
    v_xor_b32 v142, s82, v142
    v_xor_b32 v143, s83, v143
    v_xor_b32 v144, s82, v144
    v_xor_b32 v145, s83, v145
    v_xor_b32 v146, s82, v146
    v_xor_b32 v147, s83, v147
    v_or_b32 v140, v140, v141
    v_or3_b32 v140, v140, v142, v143
    v_or3_b32 v140, v140, v144, v145
    v_or3_b32 v140, v140, v146, v147
    v_cmp_ne_u32 vcc, 0, v140
    s_cbranch_vccz L_fld_12
    s_sleep 2
    buffer_load_dwordx4 v[140:143], v138, s[64:67], 0 offen sc1
    buffer_load_dwordx4 v[144:147], v138, s[64:67], 0 offen offset:896 sc1
    s_waitcnt vmcnt(0)
    s_add_u32 s94, s94, 1
    s_cmp_lt_u32 s94, 50000
    s_cbranch_scc1 L_fl_11
L_fld_12:
    s_mul_i32 s85, s84, 344064
    s_add_u32 s85, s85, 1048576
    s_mov_b32 s9, s85
    s_mul_i32 s87, s76, 28
    s_sub_u32 s88, s76, 4
    s_lshl_b32 s88, s88, 4
    s_add_u32 s88, s88, 112
    s_cmp_lt_u32 s76, 4
    s_cselect_b32 s87, s87, s88
    s_lshl_b32 s87, s87, 11
    s_add_u32 s8, s85, s87
    s_mov_b32 s12, 0
    s_cmp_eq_u32 s77, 1
    s_cselect_b32 s12, 32768, s12
    s_cmp_eq_u32 s77, 2
    s_cselect_b32 s12, 131072, s12
    s_cmp_eq_u32 s77, 3
    s_cselect_b32 s12, 106496, s12
    s_cmp_lg_u32 s78, 1
    s_cbranch_scc1 L_cg_15
    s_add_u32 m0, s6, 0
    s_add_u32 s86, s13, 917504
    buffer_load_dwordx4 v4, s[56:59], s86 offen lds
    s_add_u32 m0, s6, 1024
    s_add_u32 s86, s13, 917504
    buffer_load_dwordx4 v5, s[60:63], s86 offen lds
    s_add_u32 m0, s6, 16384
    s_add_u32 s86, s13, 917632
    buffer_load_dwordx4 v4, s[56:59], s86 offen lds
    s_add_u32 m0, s6, 17408
    s_add_u32 s86, s13, 917632
    buffer_load_dwordx4 v5, s[60:63], s86 offen lds
    s_add_u32 m0, s6, 2048
    s_add_u32 s86, s13, 946176
    buffer_load_dwordx4 v4, s[56:59], s86 offen lds
    s_add_u32 m0, s6, 3072
    s_add_u32 s86, s13, 946176
    buffer_load_dwordx4 v5, s[60:63], s86 offen lds
    s_add_u32 m0, s6, 18432
    s_add_u32 s86, s13, 946304
    buffer_load_dwordx4 v4, s[56:59], s86 offen lds
    s_add_u32 m0, s6, 19456
    s_add_u32 s86, s13, 946304
    buffer_load_dwordx4 v5, s[60:63], s86 offen lds
    s_add_u32 m0, s6, 32768
    s_add_u32 s86, s13, 1146880
    buffer_load_dwordx4 v4, s[56:59], s86 offen lds
    s_add_u32 m0, s6, 33792
    s_add_u32 s86, s13, 1146880
    buffer_load_dwordx4 v5, s[60:63], s86 offen lds
    s_add_u32 m0, s6, 49152
    s_add_u32 s86, s13, 1147008
    buffer_load_dwordx4 v4, s[56:59], s86 offen lds
    s_add_u32 m0, s6, 50176
    s_add_u32 s86, s13, 1147008
    buffer_load_dwordx4 v5, s[60:63], s86 offen lds
    s_add_u32 m0, s6, 34816
    s_add_u32 s86, s13, 1175552
    buffer_load_dwordx4 v4, s[56:59], s86 offen lds
    s_add_u32 m0, s6, 35840
    s_add_u32 s86, s13, 1175552
    buffer_load_dwordx4 v5, s[60:63], s86 offen lds
    s_add_u32 m0, s6, 51200
    s_add_u32 s86, s13, 1175680
    buffer_load_dwordx4 v4, s[56:59], s86 offen lds
    s_add_u32 m0, s6, 52224
    s_add_u32 s86, s13, 1175680
    buffer_load_dwordx4 v5, s[60:63], s86 offen lds
L_cg_15:
    s_nop 0
    v_add_u32 v6, 65536, v6
    v_add_u32 v7, 65536, v7
    v_add_u32 v8, 65536, v8
    v_add_u32 v9, 65536, v9
    ds_read_b64_tr_b16 v[16:17], v6 offset:0
    ds_read_b64_tr_b16 v[18:19], v6 offset:512
    ds_read_b64_tr_b16 v[20:21], v7 offset:0
    ds_read_b64_tr_b16 v[22:23], v7 offset:512
    ds_read_b64_tr_b16 v[24:25], v8 offset:0
    ds_read_b64_tr_b16 v[26:27], v8 offset:512
    ds_read_b64_tr_b16 v[28:29], v9 offset:0
    ds_read_b64_tr_b16 v[30:31], v9 offset:512
    ds_read_b64_tr_b16 v[32:33], v6 offset:4096
    ds_read_b64_tr_b16 v[34:35], v6 offset:4608
    ds_read_b64_tr_b16 v[36:37], v7 offset:4096
    ds_read_b64_tr_b16 v[38:39], v7 offset:4608
    ds_read_b64_tr_b16 v[40:41], v8 offset:4096
    ds_read_b64_tr_b16 v[42:43], v8 offset:4608
    s_waitcnt lgkmcnt(12)
    v_mfma_f32_32x32x16_bf16 v[64:79], v[16:19], v[160:163], v[64:79]
    ds_read_b64_tr_b16 v[44:45], v9 offset:4096
    ds_read_b64_tr_b16 v[46:47], v9 offset:4608
    s_lshl_b32 s85, s78, 9
    v_and_b32 v10, 15, v0
    v_lshlrev_b32 v10, 3, v10
    v_add_u32 v10, s85, v10
    v_add_u32 v10, 126976, v10
    s_waitcnt lgkmcnt(12)
    v_mfma_f32_32x32x16_bf16 v[80:95], v[20:23], v[160:163], v[80:95]
    ds_read_b64_tr_b16 v[16:17], v6 offset:8192
    ds_read_b64_tr_b16 v[18:19], v6 offset:8704
    ds_read_b64 v[144:145], v10 offset:0
    ds_read_b64 v[146:147], v10 offset:128
    ds_read_b64 v[148:149], v10 offset:256
    ds_read_b64 v[150:151], v10 offset:384
    s_waitcnt lgkmcnt(12)
    v_mfma_f32_32x32x16_bf16 v[96:111], v[24:27], v[160:163], v[96:111]
    ds_read_b64_tr_b16 v[20:21], v7 offset:8192
    ds_read_b64_tr_b16 v[22:23], v7 offset:8704
    s_waitcnt lgkmcnt(12)
    v_mfma_f32_32x32x16_bf16 v[112:127], v[28:31], v[160:163], v[112:127]
    ds_read_b64_tr_b16 v[24:25], v8 offset:8192
    ds_read_b64_tr_b16 v[26:27], v8 offset:8704
    s_waitcnt lgkmcnt(12)
    v_mfma_f32_32x32x16_bf16 v[64:79], v[32:35], v[164:167], v[64:79]
    ds_read_b64_tr_b16 v[28:29], v9 offset:8192
    ds_read_b64_tr_b16 v[30:31], v9 offset:8704
    s_waitcnt lgkmcnt(12)
    v_mfma_f32_32x32x16_bf16 v[80:95], v[36:39], v[164:167], v[80:95]
    ds_read_b64_tr_b16 v[32:33], v6 offset:12288
    ds_read_b64_tr_b16 v[34:35], v6 offset:12800
    s_waitcnt lgkmcnt(12)
    v_mfma_f32_32x32x16_bf16 v[96:111], v[40:43], v[164:167], v[96:111]
    ds_read_b64_tr_b16 v[36:37], v7 offset:12288
    ds_read_b64_tr_b16 v[38:39], v7 offset:12800
    s_waitcnt lgkmcnt(12)
    v_mfma_f32_32x32x16_bf16 v[112:127], v[44:47], v[164:167], v[112:127]
    ds_read_b64_tr_b16 v[40:41], v8 offset:12288
    ds_read_b64_tr_b16 v[42:43], v8 offset:12800
    s_waitcnt lgkmcnt(12)
    v_mfma_f32_32x32x16_bf16 v[64:79], v[16:19], v[168:171], v[64:79]
    ds_read_b64_tr_b16 v[44:45], v9 offset:12288
    ds_read_b64_tr_b16 v[46:47], v9 offset:12800
    s_cmp_lg_u32 s77, 0
    s_cbranch_scc1 L_nopub_13
    v_fma_f32 v152, v246, v144, v146
    v_fma_f32 v153, v246, v145, v147
    v_fma_f32 v152, -v247, v145, v152
    v_fma_f32 v153, v247, v144, v153
    v_fma_f32 v158, v246, v152, v148
    v_fma_f32 v159, v246, v153, v149
    v_fma_f32 v158, -v247, v153, v158
    v_fma_f32 v159, v247, v152, v159
    v_fma_f32 v152, v246, v158, v150
    v_fma_f32 v153, v246, v159, v151
    v_fma_f32 v152, -v247, v159, v152
    v_fma_f32 v153, v247, v158, v153
    v_mov_b32 v154, s82
    v_mov_b32 v155, s83
    s_lshl_b32 s85, s80, 1
    s_add_u32 s85, s85, s78
    s_lshl_b32 s85, s85, 4
    s_add_u32 s85, s85, s79
    s_lshl_b32 s85, s85, 8
    s_add_u32 s85, s85, 65536
    v_and_b32 v10, 15, v0
    v_lshlrev_b32 v10, 4, v10
    s_mov_b64 s[96:97], exec
    s_mov_b64 exec, 0xffff
    buffer_store_dwordx4 v[152:155], v10, s[64:67], s85 offen sc1
    s_mov_b64 exec, s[96:97]
L_nopub_13:
    s_nop 1
    v_mov_b32 v152, 0
    v_mov_b32 v153, 0
    v_mov_b32 v156, 1.0
    v_mov_b32 v157, 0
    s_cmp_le_u32 s77, 0
    s_cbranch_scc1 L_tr_14
    v_fma_f32 v158, v246, v152, v144
    v_fma_f32 v159, v246, v153, v145
    v_fma_f32 v158, -v247, v153, v158
    v_fma_f32 v153, v247, v152, v159
    v_mov_b32 v152, v158
    v_mul_f32 v158, v246, v156
    v_mul_f32 v159, v246, v157
    v_fma_f32 v158, -v247, v157, v158
    v_fma_f32 v157, v247, v156, v159
    v_mov_b32 v156, v158
    s_cmp_le_u32 s77, 1
    s_cbranch_scc1 L_tr_14
    v_fma_f32 v158, v246, v152, v146
    v_fma_f32 v159, v246, v153, v147
    v_fma_f32 v158, -v247, v153, v158
    v_fma_f32 v153, v247, v152, v159
    v_mov_b32 v152, v158
    v_mul_f32 v158, v246, v156
    v_mul_f32 v159, v246, v157
    v_fma_f32 v158, -v247, v157, v158
    v_fma_f32 v157, v247, v156, v159
    v_mov_b32 v156, v158
    s_cmp_le_u32 s77, 2
    s_cbranch_scc1 L_tr_14
    v_fma_f32 v158, v246, v152, v148
    v_fma_f32 v159, v246, v153, v149
    v_fma_f32 v158, -v247, v153, v158
    v_fma_f32 v153, v247, v152, v159
    v_mov_b32 v152, v158
    v_mul_f32 v158, v246, v156
    v_mul_f32 v159, v246, v157
    v_fma_f32 v158, -v247, v157, v158
    v_fma_f32 v157, v247, v156, v159
    v_mov_b32 v156, v158
L_tr_14:
    s_nop 1
    v_fma_f32 v158, v254, v152, v252
    v_fma_f32 v159, v254, v153, v253
    v_fma_f32 v158, -v255, v153, v158
    s_waitcnt lgkmcnt(12)
    v_mfma_f32_32x32x16_bf16 v[80:95], v[20:23], v[168:171], v[80:95]
    v_add_u32 v6, 65536, v6
    v_add_u32 v7, 65536, v7
    v_add_u32 v8, 65536, v8
    v_add_u32 v9, 65536, v9
    ds_read_b64_tr_b16 v[16:17], v6 offset:0
    ds_read_b64_tr_b16 v[18:19], v6 offset:512
    v_fma_f32 v253, v255, v152, v159
    v_mov_b32 v252, v158
    v_mul_f32 v158, v254, v156
    v_mul_f32 v159, v254, v157
    v_fma_f32 v158, -v255, v157, v158
    s_waitcnt lgkmcnt(12)
    v_mfma_f32_32x32x16_bf16 v[96:111], v[24:27], v[168:171], v[96:111]
    ds_read_b64_tr_b16 v[20:21], v7 offset:0
    ds_read_b64_tr_b16 v[22:23], v7 offset:512
    v_fma_f32 v255, v255, v156, v159
    v_mov_b32 v254, v158
    s_waitcnt lgkmcnt(12)
    v_mfma_f32_32x32x16_bf16 v[112:127], v[28:31], v[168:171], v[112:127]
    ds_read_b64_tr_b16 v[24:25], v8 offset:0
    ds_read_b64_tr_b16 v[26:27], v8 offset:512
    s_waitcnt lgkmcnt(12)
    v_mfma_f32_32x32x16_bf16 v[64:79], v[32:35], v[172:175], v[64:79]
    ds_read_b64_tr_b16 v[28:29], v9 offset:0
    ds_read_b64_tr_b16 v[30:31], v9 offset:512
    s_waitcnt lgkmcnt(12)
    v_mfma_f32_32x32x16_bf16 v[80:95], v[36:39], v[172:175], v[80:95]
    ds_read_b64_tr_b16 v[32:33], v6 offset:4096
    ds_read_b64_tr_b16 v[34:35], v6 offset:4608
    s_waitcnt lgkmcnt(12)
    v_mfma_f32_32x32x16_bf16 v[96:111], v[40:43], v[172:175], v[96:111]
    ds_read_b64_tr_b16 v[36:37], v7 offset:4096
    ds_read_b64_tr_b16 v[38:39], v7 offset:4608
    s_waitcnt lgkmcnt(12)
    v_mfma_f32_32x32x16_bf16 v[112:127], v[44:47], v[172:175], v[112:127]
    ds_read_b64_tr_b16 v[40:41], v8 offset:4096
    ds_read_b64_tr_b16 v[42:43], v8 offset:4608
    s_waitcnt lgkmcnt(12)
    v_mfma_f32_32x32x16_bf16 v[64:79], v[16:19], v[176:179], v[64:79]
    ds_read_b64_tr_b16 v[44:45], v9 offset:4096
    ds_read_b64_tr_b16 v[46:47], v9 offset:4608
    s_waitcnt lgkmcnt(12)
    v_mfma_f32_32x32x16_bf16 v[80:95], v[20:23], v[176:179], v[80:95]
    ds_read_b64_tr_b16 v[16:17], v6 offset:8192
    ds_read_b64_tr_b16 v[18:19], v6 offset:8704
    s_waitcnt lgkmcnt(12)
    v_mfma_f32_32x32x16_bf16 v[96:111], v[24:27], v[176:179], v[96:111]
    ds_read_b64_tr_b16 v[20:21], v7 offset:8192
    ds_read_b64_tr_b16 v[22:23], v7 offset:8704
    s_waitcnt lgkmcnt(12)
    v_mfma_f32_32x32x16_bf16 v[112:127], v[28:31], v[176:179], v[112:127]
    ds_read_b64_tr_b16 v[24:25], v8 offset:8192
    ds_read_b64_tr_b16 v[26:27], v8 offset:8704
    s_waitcnt lgkmcnt(12)
    v_mfma_f32_32x32x16_bf16 v[64:79], v[32:35], v[180:183], v[64:79]
    ds_read_b64_tr_b16 v[28:29], v9 offset:8192
    ds_read_b64_tr_b16 v[30:31], v9 offset:8704
    s_add_u32 s86, s8, 0
    buffer_load_dwordx4 v[128:131], v2, s[64:67], s86 offen sc1
    s_add_u32 s86, s8, 1024
    buffer_load_dwordx4 v[132:135], v2, s[64:67], s86 offen sc1
    s_waitcnt lgkmcnt(12)
    v_mfma_f32_32x32x16_bf16 v[80:95], v[36:39], v[180:183], v[80:95]
    ds_read_b64_tr_b16 v[32:33], v6 offset:12288
    ds_read_b64_tr_b16 v[34:35], v6 offset:12800
    s_add_u32 s86, s8, 2048
    buffer_load_dwordx4 v[136:139], v2, s[64:67], s86 offen sc1
    s_add_u32 s86, s8, 3072
    buffer_load_dwordx4 v[140:143], v2, s[64:67], s86 offen sc1
    s_waitcnt lgkmcnt(12)
    v_mfma_f32_32x32x16_bf16 v[96:111], v[40:43], v[180:183], v[96:111]
    ds_read_b64_tr_b16 v[36:37], v7 offset:12288
    ds_read_b64_tr_b16 v[38:39], v7 offset:12800
    s_waitcnt lgkmcnt(12)
    v_mfma_f32_32x32x16_bf16 v[112:127], v[44:47], v[180:183], v[112:127]
    ds_read_b64_tr_b16 v[40:41], v8 offset:12288
    ds_read_b64_tr_b16 v[42:43], v8 offset:12800
    s_waitcnt lgkmcnt(12)
    v_mfma_f32_32x32x16_bf16 v[64:79], v[16:19], v[184:187], v[64:79]
    ds_read_b64_tr_b16 v[44:45], v9 offset:12288
    ds_read_b64_tr_b16 v[46:47], v9 offset:12800
    s_waitcnt lgkmcnt(12)
    v_mfma_f32_32x32x16_bf16 v[80:95], v[20:23], v[184:187], v[80:95]
    s_waitcnt lgkmcnt(10)
    v_mfma_f32_32x32x16_bf16 v[96:111], v[24:27], v[184:187], v[96:111]
    s_waitcnt lgkmcnt(8)
    v_mfma_f32_32x32x16_bf16 v[112:127], v[28:31], v[184:187], v[112:127]
    s_waitcnt lgkmcnt(6)
    v_mfma_f32_32x32x16_bf16 v[64:79], v[32:35], v[188:191], v[64:79]
    s_waitcnt lgkmcnt(4)
    v_mfma_f32_32x32x16_bf16 v[80:95], v[36:39], v[188:191], v[80:95]
    s_waitcnt lgkmcnt(2)
    v_mfma_f32_32x32x16_bf16 v[96:111], v[40:43], v[188:191], v[96:111]
    s_cmp_lg_u32 s76, 0
    s_cbranch_scc1 L_cs_16
    v_and_b32 v10, 3, v0
    v_lshrrev_b32 v11, 1, v10
    s_lshl_b32 s85, s80, 1
    v_add_u32 v11, s85, v11
    v_lshlrev_b32 v11, 7, v11
    v_and_b32 v10, 1, v10
    v_lshlrev_b32 v10, 3, v10
    v_add_u32 v10, v10, v11
    s_mov_b32 s87, 4096
    buffer_load_dwordx2 v[156:157], v10, s[64:67], s87 offen sc1
    s_waitcnt vmcnt(0)
    s_mov_b32 s94, 0
L_f0_17:
    v_xor_b32 v156, s82, v156
    v_xor_b32 v157, s83, v157
    v_or_b32 v156, v156, v157
    v_cmp_ne_u32 vcc, 0, v156
    s_cbranch_vccz L_f0d_18
    s_sleep 2
    buffer_load_dwordx2 v[156:157], v10, s[64:67], s87 offen sc1
    s_waitcnt vmcnt(0)
    s_add_u32 s94, s94, 1
    s_cmp_lt_u32 s94, 50000
    s_cbranch_scc1 L_f0_17
L_f0d_18:
    s_lshl_b32 s85, s80, 10
    s_add_u32 s85, s85, 262144
    s_mov_b32 m0, 129024
    s_nop 0
    buffer_load_dwordx4 v2, s[64:67], s85 offen sc1 lds
L_cs_16:
    s_waitcnt lgkmcnt(0)
    v_mfma_f32_32x32x16_bf16 v[112:127], v[44:47], v[188:191], v[112:127]
    s_cmp_eq_u32 s78, 0
    s_cbranch_scc1 L_vw_19
    s_waitcnt vmcnt(4)
    s_branch L_vw_20
L_vw_19:
    s_waitcnt vmcnt(0)
L_vw_20:
    s_waitcnt lgkmcnt(0)
    s_barrier
    s_cmp_lg_u32 s78, 1
    s_cbranch_scc1 L_cg_23
    s_add_u32 m0, s6, 65536
    s_add_u32 s86, s13, 1376256
    buffer_load_dwordx4 v4, s[56:59], s86 offen lds
    s_add_u32 m0, s6, 66560
    s_add_u32 s86, s13, 1376256
    buffer_load_dwordx4 v5, s[60:63], s86 offen lds
    s_add_u32 m0, s6, 81920
    s_add_u32 s86, s13, 1376384
    buffer_load_dwordx4 v4, s[56:59], s86 offen lds
    s_add_u32 m0, s6, 82944
    s_add_u32 s86, s13, 1376384
    buffer_load_dwordx4 v5, s[60:63], s86 offen lds
    s_add_u32 m0, s6, 67584
    s_add_u32 s86, s13, 1404928
    buffer_load_dwordx4 v4, s[56:59], s86 offen lds
    s_add_u32 m0, s6, 68608
    s_add_u32 s86, s13, 1404928
    buffer_load_dwordx4 v5, s[60:63], s86 offen lds
    s_add_u32 m0, s6, 83968
    s_add_u32 s86, s13, 1405056
    buffer_load_dwordx4 v4, s[56:59], s86 offen lds
    s_add_u32 m0, s6, 84992
    s_add_u32 s86, s13, 1405056
    buffer_load_dwordx4 v5, s[60:63], s86 offen lds
    s_setprio 1
L_cg_23:
    s_nop 0
    v_subrev_u32 v6, 131072, v6
    v_subrev_u32 v7, 131072, v7
    v_subrev_u32 v8, 131072, v8
    v_subrev_u32 v9, 131072, v9
    ds_read_b64_tr_b16 v[16:17], v6 offset:0
    ds_read_b64_tr_b16 v[18:19], v6 offset:512
    ds_read_b64_tr_b16 v[20:21], v7 offset:0
    ds_read_b64_tr_b16 v[22:23], v7 offset:512
    ds_read_b64_tr_b16 v[24:25], v8 offset:0
    ds_read_b64_tr_b16 v[26:27], v8 offset:512
    ds_read_b64_tr_b16 v[28:29], v9 offset:0
    ds_read_b64_tr_b16 v[30:31], v9 offset:512
    ds_read_b64_tr_b16 v[32:33], v6 offset:4096
    ds_read_b64_tr_b16 v[34:35], v6 offset:4608
    ds_read_b64_tr_b16 v[36:37], v7 offset:4096
    ds_read_b64_tr_b16 v[38:39], v7 offset:4608
    ds_read_b64_tr_b16 v[40:41], v8 offset:4096
    ds_read_b64_tr_b16 v[42:43], v8 offset:4608
    s_waitcnt lgkmcnt(12)
    v_mfma_f32_32x32x16_bf16 v[64:79], v[16:19], v[192:195], v[64:79]
    ds_read_b64_tr_b16 v[44:45], v9 offset:4096
    ds_read_b64_tr_b16 v[46:47], v9 offset:4608
    s_add_u32 s86, s8, 4096
    buffer_load_dwordx4 v[144:147], v2, s[64:67], s86 offen sc1
    s_add_u32 s86, s8, 5120
    buffer_load_dwordx4 v[148:151], v2, s[64:67], s86 offen sc1
    s_add_u32 s86, s8, 6144
    buffer_load_dwordx4 v[152:155], v2, s[64:67], s86 offen sc1
    s_add_u32 s86, s8, 7168
    buffer_load_dwordx4 v[156:159], v2, s[64:67], s86 offen sc1
    v_mul_f32 v184, v249, v249
    s_waitcnt lgkmcnt(12)
    v_mfma_f32_32x32x16_bf16 v[80:95], v[20:23], v[192:195], v[80:95]
    ds_read_b64_tr_b16 v[16:17], v6 offset:8192
    ds_read_b64_tr_b16 v[18:19], v6 offset:8704
    v_mul_f32 v179, v248, v249
    v_fma_f32 v178, v248, v248, -v184
    v_add_f32 v179, v179, v179
    v_mul_f32 v180, v178, v248
    v_mul_f32 v181, v178, v249
    s_waitcnt lgkmcnt(12)
    v_mfma_f32_32x32x16_bf16 v[96:111], v[24:27], v[192:195], v[96:111]
    ds_read_b64_tr_b16 v[20:21], v7 offset:8192
    ds_read_b64_tr_b16 v[22:23], v7 offset:8704
    v_fma_f32 v180, -v179, v249, v180
    v_fma_f32 v181, v179, v248, v181
    v_mul_f32 v184, v179, v179
    v_mul_f32 v183, v178, v179
    v_fma_f32 v182, v178, v178, -v184
    s_waitcnt lgkmcnt(12)
    v_mfma_f32_32x32x16_bf16 v[112:127], v[28:31], v[192:195], v[112:127]
    ds_read_b64_tr_b16 v[24:25], v8 offset:8192
    ds_read_b64_tr_b16 v[26:27], v8 offset:8704
    v_add_f32 v183, v183, v183
    v_lshrrev_b32 v11, 4, v0
    s_sub_u32 s85, s79, 1
    v_sub_u32 v1, s85, v11
    v_and_b32 v1, 3, v1
    s_waitcnt lgkmcnt(12)
    v_mfma_f32_32x32x16_bf16 v[64:79], v[32:35], v[196:199], v[64:79]
    ds_read_b64_tr_b16 v[28:29], v9 offset:8192
    ds_read_b64_tr_b16 v[30:31], v9 offset:8704
    v_cmp_eq_u32 s[96:97], 1, v1
    v_cmp_eq_u32 s[98:99], 2, v1
    v_cmp_eq_u32 vcc, 3, v1
    v_mov_b32 v188, 1.0
    v_mov_b32 v189, 0
    s_waitcnt lgkmcnt(12)
    v_mfma_f32_32x32x16_bf16 v[80:95], v[36:39], v[196:199], v[80:95]
    ds_read_b64_tr_b16 v[32:33], v6 offset:12288
    ds_read_b64_tr_b16 v[34:35], v6 offset:12800
    v_cndmask_b32 v188, v188, v248, s[96:97]
    v_cndmask_b32 v188, v188, v178, s[98:99]
    v_cndmask_b32 v188, v188, v180, vcc
    v_cndmask_b32 v189, v189, v249, s[96:97]
    v_cndmask_b32 v189, v189, v179, s[98:99]
    s_waitcnt lgkmcnt(12)
    v_mfma_f32_32x32x16_bf16 v[96:111], v[40:43], v[196:199], v[96:111]
    ds_read_b64_tr_b16 v[36:37], v7 offset:12288
    ds_read_b64_tr_b16 v[38:39], v7 offset:12800
    v_cndmask_b32 v189, v189, v181, vcc
    s_waitcnt lgkmcnt(12)
    v_mfma_f32_32x32x16_bf16 v[112:127], v[44:47], v[196:199], v[112:127]
    ds_read_b64_tr_b16 v[40:41], v8 offset:12288
    ds_read_b64_tr_b16 v[42:43], v8 offset:12800
    s_waitcnt lgkmcnt(12)
    v_mfma_f32_32x32x16_bf16 v[64:79], v[16:19], v[200:203], v[64:79]
    ds_read_b64_tr_b16 v[44:45], v9 offset:12288
    ds_read_b64_tr_b16 v[46:47], v9 offset:12800
    s_waitcnt lgkmcnt(12)
    v_mfma_f32_32x32x16_bf16 v[80:95], v[20:23], v[200:203], v[80:95]
    ds_read_b64_tr_b16 v[16:17], v6 offset:32768
    ds_read_b64_tr_b16 v[18:19], v6 offset:33280
    s_cmp_lg_u32 s78, 1
    s_cbranch_scc1 L_cg_24
    s_waitcnt vmcnt(4)
    s_add_u32 s85, s77, 128000
    v_mov_b32 v10, s85
    v_mov_b32 v1, 1
    ds_write_b8 v10, v1
L_cg_24:
    s_nop 0
    s_waitcnt lgkmcnt(12)
    v_mfma_f32_32x32x16_bf16 v[96:111], v[24:27], v[200:203], v[96:111]
    ds_read_b64_tr_b16 v[20:21], v7 offset:32768
    ds_read_b64_tr_b16 v[22:23], v7 offset:33280
    s_waitcnt lgkmcnt(12)
    v_mfma_f32_32x32x16_bf16 v[112:127], v[28:31], v[200:203], v[112:127]
    ds_read_b64_tr_b16 v[24:25], v8 offset:32768
    ds_read_b64_tr_b16 v[26:27], v8 offset:33280
    s_waitcnt lgkmcnt(12)
    v_mfma_f32_32x32x16_bf16 v[64:79], v[32:35], v[204:207], v[64:79]
    ds_read_b64_tr_b16 v[28:29], v9 offset:32768
    ds_read_b64_tr_b16 v[30:31], v9 offset:33280
    v_lshrrev_b32 v10, 4, v0
    v_lshlrev_b32 v10, 8, v10
    v_and_b32 v1, 15, v0
    v_lshlrev_b32 v1, 4, v1
    v_add_u32 v10, v10, v1
    s_waitcnt lgkmcnt(12)
    v_mfma_f32_32x32x16_bf16 v[80:95], v[36:39], v[204:207], v[80:95]
    ds_read_b64_tr_b16 v[32:33], v6 offset:36864
    ds_read_b64_tr_b16 v[34:35], v6 offset:37376
    s_lshl_b32 s89, s80, 1
    s_add_u32 s89, s89, s78
    s_lshl_b32 s89, s89, 12
    s_add_u32 s89, s89, 65536
    buffer_load_dwordx4 v[160:163], v10, s[64:67], s89 offen offset:0 sc1
    s_waitcnt lgkmcnt(12)
    v_mfma_f32_32x32x16_bf16 v[96:111], v[40:43], v[204:207], v[96:111]
    ds_read_b64_tr_b16 v[36:37], v7 offset:36864
    ds_read_b64_tr_b16 v[38:39], v7 offset:37376
    buffer_load_dwordx4 v[164:167], v10, s[64:67], s89 offen offset:1024 sc1
    buffer_load_dwordx4 v[168:171], v10, s[64:67], s89 offen offset:2048 sc1
    buffer_load_dwordx4 v[172:175], v10, s[64:67], s89 offen offset:3072 sc1
    s_mul_i32 s86, s76, 3072
    s_add_u32 m0, s86, 131072
    s_add_u32 s86, s86, s9
    s_add_u32 s86, s86, 147456
    buffer_load_dwordx4 v2, s[64:67], s86 offen sc1 lds
    s_mul_i32 s86, s76, 3072
    s_add_u32 m0, s86, 132096
    s_add_u32 s86, s86, s9
    s_add_u32 s86, s86, 148480
    buffer_load_dwordx4 v2, s[64:67], s86 offen sc1 lds
    s_mul_i32 s86, s76, 3072
    s_add_u32 m0, s86, 133120
    s_add_u32 s86, s86, s9
    s_add_u32 s86, s86, 149504
    buffer_load_dwordx4 v2, s[64:67], s86 offen sc1 lds
    s_waitcnt lgkmcnt(12)
    v_mfma_f32_32x32x16_bf16 v[112:127], v[44:47], v[204:207], v[112:127]
    ds_read_b64_tr_b16 v[40:41], v8 offset:36864
    ds_read_b64_tr_b16 v[42:43], v8 offset:37376
    s_waitcnt lgkmcnt(12)
    v_mfma_f32_32x32x16_bf16 v[64:79], v[16:19], v[208:211], v[64:79]
    ds_read_b64_tr_b16 v[44:45], v9 offset:36864
    ds_read_b64_tr_b16 v[46:47], v9 offset:37376
    s_waitcnt lgkmcnt(12)
    v_mfma_f32_32x32x16_bf16 v[80:95], v[20:23], v[208:211], v[80:95]
    ds_read_b64_tr_b16 v[16:17], v6 offset:40960
    ds_read_b64_tr_b16 v[18:19], v6 offset:41472
    s_waitcnt lgkmcnt(12)
    v_mfma_f32_32x32x16_bf16 v[96:111], v[24:27], v[208:211], v[96:111]
    ds_read_b64_tr_b16 v[20:21], v7 offset:40960
    ds_read_b64_tr_b16 v[22:23], v7 offset:41472
    s_waitcnt lgkmcnt(12)
    v_mfma_f32_32x32x16_bf16 v[112:127], v[28:31], v[208:211], v[112:127]
    ds_read_b64_tr_b16 v[24:25], v8 offset:40960
    ds_read_b64_tr_b16 v[26:27], v8 offset:41472
    s_waitcnt lgkmcnt(12)
    v_mfma_f32_32x32x16_bf16 v[64:79], v[32:35], v[212:215], v[64:79]
    ds_read_b64_tr_b16 v[28:29], v9 offset:40960
    ds_read_b64_tr_b16 v[30:31], v9 offset:41472
    s_waitcnt vmcnt(3)
    s_mov_b32 s94, 0
L_gp_21:
    v_mov_b32 v186, 0
    v_xor_b32 v187, s82, v162
    v_xor_b32 v184, s83, v163
    v_or_b32 v187, v187, v184
    s_sub_u32 s85, s79, 0
    v_cmp_gt_i32 vcc, s85, v11
    s_nop 1
    v_cndmask_b32 v187, 0, v187, vcc
    v_or_b32 v186, v186, v187
    v_xor_b32 v187, s82, v166
    v_xor_b32 v184, s83, v167
    v_or_b32 v187, v187, v184
    s_sub_u32 s85, s79, 4
    v_cmp_gt_i32 vcc, s85, v11
    s_nop 1
    v_cndmask_b32 v187, 0, v187, vcc
    v_or_b32 v186, v186, v187
    v_xor_b32 v187, s82, v170
    v_xor_b32 v184, s83, v171
    v_or_b32 v187, v187, v184
    s_sub_u32 s85, s79, 8
    v_cmp_gt_i32 vcc, s85, v11
    s_nop 1
    v_cndmask_b32 v187, 0, v187, vcc
    v_or_b32 v186, v186, v187
    v_xor_b32 v187, s82, v174
    v_xor_b32 v184, s83, v175
    v_or_b32 v187, v187, v184
    s_sub_u32 s85, s79, 12
    v_cmp_gt_i32 vcc, s85, v11
    s_nop 1
    v_cndmask_b32 v187, 0, v187, vcc
    v_or_b32 v186, v186, v187
    v_cmp_ne_u32 vcc, 0, v186
    s_cbranch_vccz L_gok_22
    s_sleep 2
    v_lshrrev_b32 v10, 4, v0
    v_lshlrev_b32 v10, 8, v10
    v_and_b32 v1, 15, v0
    v_lshlrev_b32 v1, 4, v1
    v_add_u32 v10, v10, v1
    s_lshl_b32 s89, s80, 1
    s_add_u32 s89, s89, s78
    s_lshl_b32 s89, s89, 12
    s_add_u32 s89, s89, 65536
    buffer_load_dwordx4 v[160:163], v10, s[64:67], s89 offen offset:0 sc1
    buffer_load_dwordx4 v[164:167], v10, s[64:67], s89 offen offset:1024 sc1
    buffer_load_dwordx4 v[168:171], v10, s[64:67], s89 offen offset:2048 sc1
    buffer_load_dwordx4 v[172:175], v10, s[64:67], s89 offen offset:3072 sc1
    s_waitcnt vmcnt(0)
    s_add_u32 s94, s94, 1
    s_cmp_lt_u32 s94, 50000
    s_cbranch_scc1 L_gp_21
L_gok_22:
    s_nop 1
    v_mov_b32 v176, 0
    v_mov_b32 v177, 0
    v_fma_f32 v186, v182, v176, v160
    v_fma_f32 v187, v182, v177, v161
    v_fma_f32 v186, -v183, v177, v186
    v_fma_f32 v187, v183, v176, v187
    s_waitcnt lgkmcnt(12)
    v_mfma_f32_32x32x16_bf16 v[80:95], v[36:39], v[212:215], v[80:95]
    ds_read_b64_tr_b16 v[32:33], v6 offset:45056
    ds_read_b64_tr_b16 v[34:35], v6 offset:45568
    s_sub_u32 s85, s79, 0
    v_cmp_gt_i32 vcc, s85, v11
    s_nop 1
    v_cndmask_b32 v176, v176, v186, vcc
    v_cndmask_b32 v177, v177, v187, vcc
    v_fma_f32 v186, v182, v176, v164
    v_fma_f32 v187, v182, v177, v165
    v_fma_f32 v186, -v183, v177, v186
    s_waitcnt lgkmcnt(12)
    v_mfma_f32_32x32x16_bf16 v[96:111], v[40:43], v[212:215], v[96:111]
    ds_read_b64_tr_b16 v[36:37], v7 offset:45056
    ds_read_b64_tr_b16 v[38:39], v7 offset:45568
    v_fma_f32 v187, v183, v176, v187
    s_sub_u32 s85, s79, 4
    v_cmp_gt_i32 vcc, s85, v11
    s_nop 1
    v_cndmask_b32 v176, v176, v186, vcc
    v_cndmask_b32 v177, v177, v187, vcc
    v_fma_f32 v186, v182, v176, v168
    v_fma_f32 v187, v182, v177, v169
    s_waitcnt lgkmcnt(12)
    v_mfma_f32_32x32x16_bf16 v[112:127], v[44:47], v[212:215], v[112:127]
    ds_read_b64_tr_b16 v[40:41], v8 offset:45056
    ds_read_b64_tr_b16 v[42:43], v8 offset:45568
    v_fma_f32 v186, -v183, v177, v186
    v_fma_f32 v187, v183, v176, v187
    s_sub_u32 s85, s79, 8
    v_cmp_gt_i32 vcc, s85, v11
    s_nop 1
    v_cndmask_b32 v176, v176, v186, vcc
    v_cndmask_b32 v177, v177, v187, vcc
    v_fma_f32 v186, v182, v176, v172
    s_waitcnt lgkmcnt(12)
    v_mfma_f32_32x32x16_bf16 v[64:79], v[16:19], v[216:219], v[64:79]
    ds_read_b64_tr_b16 v[44:45], v9 offset:45056
    ds_read_b64_tr_b16 v[46:47], v9 offset:45568
    v_fma_f32 v187, v182, v177, v173
    v_fma_f32 v186, -v183, v177, v186
    v_fma_f32 v187, v183, v176, v187
    s_sub_u32 s85, s79, 12
    v_cmp_gt_i32 vcc, s85, v11
    s_nop 1
    v_cndmask_b32 v176, v176, v186, vcc
    v_cndmask_b32 v177, v177, v187, vcc
    s_waitcnt lgkmcnt(12)
    v_mfma_f32_32x32x16_bf16 v[80:95], v[20:23], v[216:219], v[80:95]
    s_mov_b32 s3, 0
L_sw_25:
    v_mov_b32 v15, 128000
    ds_read_b32 v15, v15
    s_waitcnt lgkmcnt(0)
    v_readfirstlane_b32 s90, v15
    s_nop 0
    s_cmp_eq_u32 s90, 0x01010101
    s_cbranch_scc1 L_swd_26
    s_add_u32 s3, s3, 1
    s_cmp_lt_u32 s3, 100000
    s_cbranch_scc1 L_sw_25
L_swd_26:
    v_add_u32 v6, 65536, v6
    v_add_u32 v7, 65536, v7
    v_add_u32 v8, 65536, v8
    v_add_u32 v9, 65536, v9
    ds_read_b64_tr_b16 v[16:17], v6 offset:0
    ds_read_b64_tr_b16 v[18:19], v6 offset:512
    v_mul_f32 v186, v188, v176
    v_mul_f32 v187, v188, v177
    v_fma_f32 v186, -v189, v177, v186
    v_fma_f32 v187, v189, v176, v187
    v_mov_b32 v176, v186
    v_mov_b32 v177, v187
    s_nop 0
    v_permlane16_swap_b32 v176, v186
    s_waitcnt lgkmcnt(12)
    v_mfma_f32_32x32x16_bf16 v[96:111], v[24:27], v[216:219], v[96:111]
    ds_read_b64_tr_b16 v[20:21], v7 offset:0
    ds_read_b64_tr_b16 v[22:23], v7 offset:512
    v_permlane16_swap_b32 v177, v187
    v_add_f32 v176, v176, v186
    v_add_f32 v177, v177, v187
    v_mov_b32 v186, v176
    v_mov_b32 v187, v177
    s_nop 0
    v_permlane32_swap_b32 v176, v186
    v_permlane32_swap_b32 v177, v187
    s_waitcnt lgkmcnt(12)
    v_mfma_f32_32x32x16_bf16 v[112:127], v[28:31], v[216:219], v[112:127]
    ds_read_b64_tr_b16 v[24:25], v8 offset:0
    ds_read_b64_tr_b16 v[26:27], v8 offset:512
    v_add_f32 v184, v176, v186
    v_add_f32 v185, v177, v187
    v_fma_f32 v176, v254, v184, v252
    v_fma_f32 v177, v254, v185, v253
    v_fma_f32 v176, -v255, v185, v176
    v_fma_f32 v177, v255, v184, v177
    v_fma_f32 v178, v240, v176, v48
    s_waitcnt lgkmcnt(12)
    v_mfma_f32_32x32x16_bf16 v[64:79], v[32:35], v[220:223], v[64:79]
    ds_read_b64_tr_b16 v[28:29], v9 offset:0
    ds_read_b64_tr_b16 v[30:31], v9 offset:512
    v_fma_f32 v179, v240, v177, v56
    v_fma_f32 v178, -v241, v177, v178
    v_fma_f32 v179, v241, v176, v179
    v_mul_f32 v160, v250, v178
    v_mul_f32 v168, -v250, v179
    v_fma_f32 v160, -v251, v179, v160
    v_fma_f32 v168, -v251, v178, v168
    s_waitcnt lgkmcnt(12)
    v_mfma_f32_32x32x16_bf16 v[80:95], v[36:39], v[220:223], v[80:95]
    ds_read_b64_tr_b16 v[32:33], v6 offset:4096
    ds_read_b64_tr_b16 v[34:35], v6 offset:4608
    v_fma_f32 v176, v240, v178, v49
    v_fma_f32 v177, v240, v179, v57
    v_fma_f32 v176, -v241, v179, v176
    v_fma_f32 v177, v241, v178, v177
    v_mul_f32 v161, v250, v176
    v_mul_f32 v169, -v250, v177
    v_fma_f32 v161, -v251, v177, v161
    s_waitcnt lgkmcnt(12)
    v_mfma_f32_32x32x16_bf16 v[96:111], v[40:43], v[220:223], v[96:111]
    ds_read_b64_tr_b16 v[36:37], v7 offset:4096
    ds_read_b64_tr_b16 v[38:39], v7 offset:4608
    v_fma_f32 v169, -v251, v176, v169
    v_fma_f32 v178, v240, v176, v50
    v_fma_f32 v179, v240, v177, v58
    v_fma_f32 v178, -v241, v177, v178
    v_fma_f32 v179, v241, v176, v179
    v_mul_f32 v162, v250, v178
    v_mul_f32 v170, -v250, v179
    s_waitcnt lgkmcnt(12)
    v_mfma_f32_32x32x16_bf16 v[112:127], v[44:47], v[220:223], v[112:127]
    ds_read_b64_tr_b16 v[40:41], v8 offset:4096
    ds_read_b64_tr_b16 v[42:43], v8 offset:4608
    v_fma_f32 v162, -v251, v179, v162
    v_fma_f32 v170, -v251, v178, v170
    v_fma_f32 v176, v240, v178, v51
    v_fma_f32 v177, v240, v179, v59
    v_fma_f32 v176, -v241, v179, v176
    v_fma_f32 v177, v241, v178, v177
    v_mul_f32 v163, v250, v176
    s_waitcnt lgkmcnt(12)
    v_mfma_f32_32x32x16_bf16 v[64:79], v[16:19], v[224:227], v[64:79]
    ds_read_b64_tr_b16 v[44:45], v9 offset:4096
    ds_read_b64_tr_b16 v[46:47], v9 offset:4608
    v_mul_f32 v171, -v250, v177
    v_fma_f32 v163, -v251, v177, v163
    v_fma_f32 v171, -v251, v176, v171
    v_fma_f32 v178, v240, v176, v52
    v_fma_f32 v179, v240, v177, v60
    v_fma_f32 v178, -v241, v177, v178
    v_fma_f32 v179, v241, v176, v179
    s_waitcnt lgkmcnt(12)
    v_mfma_f32_32x32x16_bf16 v[80:95], v[20:23], v[224:227], v[80:95]
    ds_read_b64_tr_b16 v[16:17], v6 offset:8192
    ds_read_b64_tr_b16 v[18:19], v6 offset:8704
    v_mul_f32 v164, v250, v178
    v_mul_f32 v172, -v250, v179
    v_fma_f32 v164, -v251, v179, v164
    v_fma_f32 v172, -v251, v178, v172
    v_fma_f32 v176, v240, v178, v53
    v_fma_f32 v177, v240, v179, v61
    v_fma_f32 v176, -v241, v179, v176
    s_waitcnt lgkmcnt(12)
    v_mfma_f32_32x32x16_bf16 v[96:111], v[24:27], v[224:227], v[96:111]
    ds_read_b64_tr_b16 v[20:21], v7 offset:8192
    ds_read_b64_tr_b16 v[22:23], v7 offset:8704
    v_fma_f32 v177, v241, v178, v177
    v_mul_f32 v165, v250, v176
    v_mul_f32 v173, -v250, v177
    v_fma_f32 v165, -v251, v177, v165
    v_fma_f32 v173, -v251, v176, v173
    v_fma_f32 v178, v240, v176, v54
    v_fma_f32 v179, v240, v177, v62
    s_waitcnt lgkmcnt(12)
    v_mfma_f32_32x32x16_bf16 v[112:127], v[28:31], v[224:227], v[112:127]
    ds_read_b64_tr_b16 v[24:25], v8 offset:8192
    ds_read_b64_tr_b16 v[26:27], v8 offset:8704
    v_fma_f32 v178, -v241, v177, v178
    v_fma_f32 v179, v241, v176, v179
    v_mul_f32 v166, v250, v178
    v_mul_f32 v174, -v250, v179
    v_fma_f32 v166, -v251, v179, v166
    v_fma_f32 v174, -v251, v178, v174
    v_fma_f32 v176, v240, v178, v55
    s_waitcnt lgkmcnt(12)
    v_mfma_f32_32x32x16_bf16 v[64:79], v[32:35], v[228:231], v[64:79]
    ds_read_b64_tr_b16 v[28:29], v9 offset:8192
    ds_read_b64_tr_b16 v[30:31], v9 offset:8704
    v_fma_f32 v177, v240, v179, v63
    v_fma_f32 v176, -v241, v179, v176
    v_fma_f32 v177, v241, v178, v177
    v_mul_f32 v167, v250, v176
    v_mul_f32 v175, -v250, v177
    v_fma_f32 v167, -v251, v177, v167
    v_fma_f32 v175, -v251, v176, v175
    s_waitcnt lgkmcnt(12)
    v_mfma_f32_32x32x16_bf16 v[80:95], v[36:39], v[228:231], v[80:95]
    ds_read_b64_tr_b16 v[32:33], v6 offset:12288
    ds_read_b64_tr_b16 v[34:35], v6 offset:12800
    v_and_b32 v10, 15, v0
    v_lshlrev_b32 v10, 6, v10
    v_lshrrev_b32 v11, 4, v0
    v_lshlrev_b32 v1, 4, v11
    v_add_u32 v10, v10, v1
    v_add_u32 v10, s4, v10
    v_add_u32 v10, 98304, v10
    s_waitcnt lgkmcnt(12)
    v_mfma_f32_32x32x16_bf16 v[96:111], v[40:43], v[228:231], v[96:111]
    ds_read_b64_tr_b16 v[36:37], v7 offset:12288
    ds_read_b64_tr_b16 v[38:39], v7 offset:12800
    v_cvt_pk_bf16_f32 v180, v160, v161
    v_cvt_pk_bf16_f32 v181, v162, v163
    v_cvt_pk_bf16_f32 v182, v164, v165
    v_cvt_pk_bf16_f32 v183, v166, v167
    v_cvt_pk_bf16_f32 v184, v168, v169
    v_cvt_pk_bf16_f32 v185, v170, v171
    v_cvt_pk_bf16_f32 v186, v172, v173
    s_waitcnt lgkmcnt(12)
    v_mfma_f32_32x32x16_bf16 v[112:127], v[44:47], v[228:231], v[112:127]
    ds_read_b64_tr_b16 v[40:41], v8 offset:12288
    ds_read_b64_tr_b16 v[42:43], v8 offset:12800
    v_cvt_pk_bf16_f32 v187, v174, v175
    ds_write_b128 v10, v[180:183]
    ds_write_b128 v10, v[184:187] offset:1024
    v_and_b32 v1, 1, v11
    v_lshrrev_b32 v11, 1, v11
    v_lshlrev_b32 v11, 10, v11
    v_lshlrev_b32 v1, 4, v1
    s_waitcnt lgkmcnt(12)
    v_mfma_f32_32x32x16_bf16 v[64:79], v[16:19], v[232:235], v[64:79]
    ds_read_b64_tr_b16 v[44:45], v9 offset:12288
    ds_read_b64_tr_b16 v[46:47], v9 offset:12800
    v_add_u32 v11, v11, v1
    v_lshrrev_b32 v1, 2, v0
    v_and_b32 v1, 3, v1
    v_lshlrev_b32 v1, 6, v1
    v_add_u32 v11, v11, v1
    v_and_b32 v1, 1, v0
    v_lshlrev_b32 v1, 5, v1
    s_waitcnt lgkmcnt(12)
    v_mfma_f32_32x32x16_bf16 v[80:95], v[20:23], v[232:235], v[80:95]
    v_add_u32 v11, v11, v1
    v_lshrrev_b32 v1, 1, v0
    v_and_b32 v1, 1, v1
    v_lshlrev_b32 v1, 3, v1
    v_add_u32 v11, v11, v1
    v_add_u32 v11, s4, v11
    v_add_u32 v11, 98304, v11
    s_waitcnt lgkmcnt(10)
    v_mfma_f32_32x32x16_bf16 v[96:111], v[24:27], v[232:235], v[96:111]
    s_waitcnt lgkmcnt(8)
    v_mfma_f32_32x32x16_bf16 v[112:127], v[28:31], v[232:235], v[112:127]
    s_waitcnt lgkmcnt(6)
    v_mfma_f32_32x32x16_bf16 v[64:79], v[32:35], v[236:239], v[64:79]
    s_waitcnt lgkmcnt(0)
    ds_read_b64_tr_b16 v[160:161], v11 offset:0
    ds_read_b64_tr_b16 v[162:163], v11 offset:256
    ds_read_b64_tr_b16 v[164:165], v11 offset:512
    ds_read_b64_tr_b16 v[166:167], v11 offset:768
    s_waitcnt lgkmcnt(4)
    v_mfma_f32_32x32x16_bf16 v[80:95], v[36:39], v[236:239], v[80:95]
    s_waitcnt lgkmcnt(2)
    v_mfma_f32_32x32x16_bf16 v[96:111], v[40:43], v[236:239], v[96:111]
    s_lshl_b32 s88, s79, 2
    s_add_u32 s88, s88, s77
    s_mul_i32 s88, s88, 172032
    s_add_u32 s88, s88, 4194304
    s_lshl_b32 s85, s80, 1
    s_add_u32 s85, s85, s78
    s_lshl_b32 s85, s85, 11
    s_waitcnt lgkmcnt(0)
    v_mfma_f32_32x32x16_bf16 v[112:127], v[44:47], v[236:239], v[112:127]
    s_add_u32 s85, s85, 114688
    s_add_u32 s88, s88, s85
    s_waitcnt lgkmcnt(0)
    buffer_store_dwordx4 v[160:163], v2, s[64:67], s88 offen offset:0 sc1
    buffer_store_dwordx4 v[164:167], v2, s[64:67], s88 offen offset:1024 sc1
    s_lshl_b32 s88, s79, 2
    s_add_u32 s88, s88, s77
    s_mul_i32 s88, s88, 172032
    s_add_u32 s88, s88, 4194304
    s_lshl_b32 s85, s80, 3
    s_lshl_b32 s86, s78, 2
    s_add_u32 s85, s85, s86
    s_lshl_b32 s86, s85, 10
    s_add_u32 s6, s88, s86
    v_lshrrev_b32 v10, 5, v0
    v_lshlrev_b32 v10, 4, v10
    s_lshl_b32 s85, s78, 8
    v_add_u32 v10, s85, v10
    v_add_u32 v10, 129024, v10
    ds_read_b128 v[16:19], v10 offset:0
    ds_read_b128 v[20:23], v10 offset:32
    ds_read_b128 v[24:27], v10 offset:512
    ds_read_b128 v[28:31], v10 offset:544
    ds_read_b128 v[32:35], v10 offset:64
    ds_read_b128 v[36:39], v10 offset:96
    ds_read_b128 v[40:43], v10 offset:576
    ds_read_b128 v[44:47], v10 offset:608
    s_waitcnt lgkmcnt(4)
    v_fmac_f32 v64, v16, v12
    v_fmac_f32 v65, v17, v12
    v_fmac_f32 v66, v18, v12
    v_fmac_f32 v67, v19, v12
    v_fmac_f32 v68, v20, v12
    v_fmac_f32 v69, v21, v12
    v_fmac_f32 v70, v22, v12
    v_fmac_f32 v71, v23, v12
    v_fmac_f32 v72, v24, v12
    v_fmac_f32 v73, v25, v12
    v_fmac_f32 v74, v26, v12
    v_fmac_f32 v75, v27, v12
    v_fmac_f32 v76, v28, v12
    v_fmac_f32 v77, v29, v12
    v_fmac_f32 v78, v30, v12
    v_fmac_f32 v79, v31, v12
    ds_read_b128 v[16:19], v10 offset:128
    ds_read_b128 v[20:23], v10 offset:160
    ds_read_b128 v[24:27], v10 offset:640
    ds_read_b128 v[28:31], v10 offset:672
    v_mul_f32 v64, v13, v64
    v_mul_f32 v65, v13, v65
    v_mul_f32 v66, v13, v66
    v_mul_f32 v67, v13, v67
    v_mul_f32 v68, v13, v68
    v_mul_f32 v69, v13, v69
    v_mul_f32 v70, v13, v70
    v_mul_f32 v71, v13, v71
    v_exp_f32 v64, v64
    v_exp_f32 v65, v65
    v_exp_f32 v66, v66
    v_exp_f32 v67, v67
    v_exp_f32 v68, v68
    v_exp_f32 v69, v69
    v_exp_f32 v70, v70
    v_exp_f32 v71, v71
    v_fma_f32 v64, v64, v14, v14
    v_fma_f32 v65, v65, v14, v14
    v_fma_f32 v66, v66, v14, v14
    v_fma_f32 v67, v67, v14, v14
    v_fma_f32 v68, v68, v14, v14
    v_fma_f32 v69, v69, v14, v14
    v_fma_f32 v70, v70, v14, v14
    v_fma_f32 v71, v71, v14, v14
    v_rcp_f32 v64, v64
    v_rcp_f32 v65, v65
    v_rcp_f32 v66, v66
    v_rcp_f32 v67, v67
    v_rcp_f32 v68, v68
    v_rcp_f32 v69, v69
    v_rcp_f32 v70, v70
    v_rcp_f32 v71, v71
    v_mul_f32 v64, v72, v64
    v_mul_f32 v65, v73, v65
    v_mul_f32 v66, v74, v66
    v_mul_f32 v67, v75, v67
    v_mul_f32 v68, v76, v68
    v_mul_f32 v69, v77, v69
    v_mul_f32 v70, v78, v70
    v_mul_f32 v71, v79, v71
    v_cvt_pk_bf16_f32 v72, v64, v65
    v_cvt_pk_bf16_f32 v73, v66, v67
    v_cvt_pk_bf16_f32 v74, v68, v69
    v_cvt_pk_bf16_f32 v75, v70, v71
    buffer_store_dwordx4 v[72:75], v2, s[64:67], s6 offen offset:0 sc1
    s_add_u32 s86, s8, 8192
    buffer_load_dwordx4 v[160:163], v2, s[64:67], s86 offen sc1
    s_add_u32 s86, s8, 9216
    buffer_load_dwordx4 v[164:167], v2, s[64:67], s86 offen sc1
    s_add_u32 s86, s8, 10240
    buffer_load_dwordx4 v[168:171], v2, s[64:67], s86 offen sc1
    s_add_u32 s86, s8, 11264
    buffer_load_dwordx4 v[172:175], v2, s[64:67], s86 offen sc1
    s_waitcnt lgkmcnt(4)
    v_fmac_f32 v80, v32, v12
    v_fmac_f32 v81, v33, v12
    v_fmac_f32 v82, v34, v12
    v_fmac_f32 v83, v35, v12
    v_fmac_f32 v84, v36, v12
    v_fmac_f32 v85, v37, v12
    v_fmac_f32 v86, v38, v12
    v_fmac_f32 v87, v39, v12
    v_fmac_f32 v88, v40, v12
    v_fmac_f32 v89, v41, v12
    v_fmac_f32 v90, v42, v12
    v_fmac_f32 v91, v43, v12
    v_fmac_f32 v92, v44, v12
    v_fmac_f32 v93, v45, v12
    v_fmac_f32 v94, v46, v12
    v_fmac_f32 v95, v47, v12
    ds_read_b128 v[32:35], v10 offset:192
    ds_read_b128 v[36:39], v10 offset:224
    ds_read_b128 v[40:43], v10 offset:704
    ds_read_b128 v[44:47], v10 offset:736
    v_mul_f32 v80, v13, v80
    v_mul_f32 v81, v13, v81
    v_mul_f32 v82, v13, v82
    v_mul_f32 v83, v13, v83
    v_mul_f32 v84, v13, v84
    v_mul_f32 v85, v13, v85
    v_mul_f32 v86, v13, v86
    v_mul_f32 v87, v13, v87
    v_exp_f32 v80, v80
    v_exp_f32 v81, v81
    v_exp_f32 v82, v82
    v_exp_f32 v83, v83
    v_exp_f32 v84, v84
    v_exp_f32 v85, v85
    v_exp_f32 v86, v86
    v_exp_f32 v87, v87
    v_fma_f32 v80, v80, v14, v14
    v_fma_f32 v81, v81, v14, v14
    v_fma_f32 v82, v82, v14, v14
    v_fma_f32 v83, v83, v14, v14
    v_fma_f32 v84, v84, v14, v14
    v_fma_f32 v85, v85, v14, v14
    v_fma_f32 v86, v86, v14, v14
    v_fma_f32 v87, v87, v14, v14
    v_rcp_f32 v80, v80
    v_rcp_f32 v81, v81
    v_rcp_f32 v82, v82
    v_rcp_f32 v83, v83
    v_rcp_f32 v84, v84
    v_rcp_f32 v85, v85
    v_rcp_f32 v86, v86
    v_rcp_f32 v87, v87
    v_mul_f32 v80, v88, v80
    v_mul_f32 v81, v89, v81
    v_mul_f32 v82, v90, v82
    v_mul_f32 v83, v91, v83
    v_mul_f32 v84, v92, v84
    v_mul_f32 v85, v93, v85
    v_mul_f32 v86, v94, v86
    v_mul_f32 v87, v95, v87
    v_cvt_pk_bf16_f32 v88, v80, v81
    v_cvt_pk_bf16_f32 v89, v82, v83
    v_cvt_pk_bf16_f32 v90, v84, v85
    v_cvt_pk_bf16_f32 v91, v86, v87
    buffer_store_dwordx4 v[88:91], v2, s[64:67], s6 offen offset:1024 sc1
    s_add_u32 s86, s8, 12288
    buffer_load_dwordx4 v[176:179], v2, s[64:67], s86 offen sc1
    s_add_u32 s86, s8, 13312
    buffer_load_dwordx4 v[180:183], v2, s[64:67], s86 offen sc1
    s_add_u32 s86, s8, 14336
    buffer_load_dwordx4 v[184:187], v2, s[64:67], s86 offen sc1
    s_add_u32 s86, s8, 15360
    buffer_load_dwordx4 v[188:191], v2, s[64:67], s86 offen sc1
    s_waitcnt lgkmcnt(4)
    v_fmac_f32 v96, v16, v12
    v_fmac_f32 v97, v17, v12
    v_fmac_f32 v98, v18, v12
    v_fmac_f32 v99, v19, v12
    v_fmac_f32 v100, v20, v12
    v_fmac_f32 v101, v21, v12
    v_fmac_f32 v102, v22, v12
    v_fmac_f32 v103, v23, v12
    v_fmac_f32 v104, v24, v12
    v_fmac_f32 v105, v25, v12
    v_fmac_f32 v106, v26, v12
    v_fmac_f32 v107, v27, v12
    v_fmac_f32 v108, v28, v12
    v_fmac_f32 v109, v29, v12
    v_fmac_f32 v110, v30, v12
    v_fmac_f32 v111, v31, v12
    v_mul_f32 v96, v13, v96
    v_mul_f32 v97, v13, v97
    v_mul_f32 v98, v13, v98
    v_mul_f32 v99, v13, v99
    v_mul_f32 v100, v13, v100
    v_mul_f32 v101, v13, v101
    v_mul_f32 v102, v13, v102
    v_mul_f32 v103, v13, v103
    v_exp_f32 v96, v96
    v_exp_f32 v97, v97
    v_exp_f32 v98, v98
    v_exp_f32 v99, v99
    v_exp_f32 v100, v100
    v_exp_f32 v101, v101
    v_exp_f32 v102, v102
    v_exp_f32 v103, v103
    v_fma_f32 v96, v96, v14, v14
    v_fma_f32 v97, v97, v14, v14
    v_fma_f32 v98, v98, v14, v14
    v_fma_f32 v99, v99, v14, v14
    v_fma_f32 v100, v100, v14, v14
    v_fma_f32 v101, v101, v14, v14
    v_fma_f32 v102, v102, v14, v14
    v_fma_f32 v103, v103, v14, v14
    v_rcp_f32 v96, v96
    v_rcp_f32 v97, v97
    v_rcp_f32 v98, v98
    v_rcp_f32 v99, v99
    v_rcp_f32 v100, v100
    v_rcp_f32 v101, v101
    v_rcp_f32 v102, v102
    v_rcp_f32 v103, v103
    v_mul_f32 v96, v104, v96
    v_mul_f32 v97, v105, v97
    v_mul_f32 v98, v106, v98
    v_mul_f32 v99, v107, v99
    v_mul_f32 v100, v108, v100
    v_mul_f32 v101, v109, v101
    v_mul_f32 v102, v110, v102
    v_mul_f32 v103, v111, v103
    v_cvt_pk_bf16_f32 v104, v96, v97
    v_cvt_pk_bf16_f32 v105, v98, v99
    v_cvt_pk_bf16_f32 v106, v100, v101
    v_cvt_pk_bf16_f32 v107, v102, v103
    buffer_store_dwordx4 v[104:107], v2, s[64:67], s6 offen offset:2048 sc1
    s_cmp_eq_u32 s76, 7
    s_cbranch_scc1 L_b2s_27
    s_add_u32 s86, s8, 16384
    buffer_load_dwordx4 v[192:195], v2, s[64:67], s86 offen sc1
    s_add_u32 s86, s8, 17408
    buffer_load_dwordx4 v[196:199], v2, s[64:67], s86 offen sc1
L_b2s_27:
    s_cmp_eq_u32 s76, 7
    s_cbranch_scc1 L_b2s_28
    s_add_u32 s86, s8, 18432
    buffer_load_dwordx4 v[200:203], v2, s[64:67], s86 offen sc1
    s_add_u32 s86, s8, 19456
    buffer_load_dwordx4 v[204:207], v2, s[64:67], s86 offen sc1
L_b2s_28:
    s_waitcnt lgkmcnt(0)
    v_fmac_f32 v112, v32, v12
    v_fmac_f32 v113, v33, v12
    v_fmac_f32 v114, v34, v12
    v_fmac_f32 v115, v35, v12
    v_fmac_f32 v116, v36, v12
    v_fmac_f32 v117, v37, v12
    v_fmac_f32 v118, v38, v12
    v_fmac_f32 v119, v39, v12
    v_fmac_f32 v120, v40, v12
    v_fmac_f32 v121, v41, v12
    v_fmac_f32 v122, v42, v12
    v_fmac_f32 v123, v43, v12
    v_fmac_f32 v124, v44, v12
    v_fmac_f32 v125, v45, v12
    v_fmac_f32 v126, v46, v12
    v_fmac_f32 v127, v47, v12
    v_mul_f32 v112, v13, v112
    v_mul_f32 v113, v13, v113
    v_mul_f32 v114, v13, v114
    v_mul_f32 v115, v13, v115
    v_mul_f32 v116, v13, v116
    v_mul_f32 v117, v13, v117
    v_mul_f32 v118, v13, v118
    v_mul_f32 v119, v13, v119
    v_exp_f32 v112, v112
    v_exp_f32 v113, v113
    v_exp_f32 v114, v114
    v_exp_f32 v115, v115
    v_exp_f32 v116, v116
    v_exp_f32 v117, v117
    v_exp_f32 v118, v118
    v_exp_f32 v119, v119
    v_fma_f32 v112, v112, v14, v14
    v_fma_f32 v113, v113, v14, v14
    v_fma_f32 v114, v114, v14, v14
    v_fma_f32 v115, v115, v14, v14
    v_fma_f32 v116, v116, v14, v14
    v_fma_f32 v117, v117, v14, v14
    v_fma_f32 v118, v118, v14, v14
    v_fma_f32 v119, v119, v14, v14
    v_rcp_f32 v112, v112
    v_rcp_f32 v113, v113
    v_rcp_f32 v114, v114
    v_rcp_f32 v115, v115
    v_rcp_f32 v116, v116
    v_rcp_f32 v117, v117
    v_rcp_f32 v118, v118
    v_rcp_f32 v119, v119
    v_mul_f32 v112, v120, v112
    v_mul_f32 v113, v121, v113
    v_mul_f32 v114, v122, v114
    v_mul_f32 v115, v123, v115
    v_mul_f32 v116, v124, v116
    v_mul_f32 v117, v125, v117
    v_mul_f32 v118, v126, v118
    v_mul_f32 v119, v127, v119
    v_cvt_pk_bf16_f32 v120, v112, v113
    v_cvt_pk_bf16_f32 v121, v114, v115
    v_cvt_pk_bf16_f32 v122, v116, v117
    v_cvt_pk_bf16_f32 v123, v118, v119
    buffer_store_dwordx4 v[120:123], v2, s[64:67], s6 offen offset:3072 sc1
    s_cmp_eq_u32 s76, 7
    s_cbranch_scc1 L_b2s_29
    s_add_u32 s86, s8, 20480
    buffer_load_dwordx4 v[208:211], v2, s[64:67], s86 offen sc1
    s_add_u32 s86, s8, 21504
    buffer_load_dwordx4 v[212:215], v2, s[64:67], s86 offen sc1
L_b2s_29:
    s_cmp_eq_u32 s76, 7
    s_cbranch_scc1 L_b2s_30
    s_add_u32 s86, s8, 22528
    buffer_load_dwordx4 v[216:219], v2, s[64:67], s86 offen sc1
    s_add_u32 s86, s8, 23552
    buffer_load_dwordx4 v[220:223], v2, s[64:67], s86 offen sc1
L_b2s_30:
    s_waitcnt vmcnt(0)
    s_setprio 0
    s_barrier
    s_cmp_lg_u32 s76, 4
    s_cbranch_scc1 L_nf2_31
    s_mul_i32 s85, s79, 1792
    s_lshl_b32 s86, s80, 3
    s_add_u32 s85, s85, s86
    s_add_u32 s85, s85, 16384
    v_lshlrev_b32 v12, 7, v0
    v_mov_b32 v10, s82
    v_mov_b32 v11, s83
    s_mov_b64 s[96:97], exec
    s_mov_b64 exec, 16383
    buffer_store_dwordx2 v[10:11], v12, s[64:67], s85 offen sc1
    s_mov_b64 exec, s[96:97]
L_nf2_31:
    s_cmp_eq_u32 s76, 7
    s_cbranch_scc1 L_b2s_32
    s_add_u32 s86, s8, 24576
    buffer_load_dwordx4 v[224:227], v2, s[64:67], s86 offen sc1
    s_add_u32 s86, s8, 25600
    buffer_load_dwordx4 v[228:231], v2, s[64:67], s86 offen sc1
L_b2s_32:
    s_cmp_eq_u32 s76, 7
    s_cbranch_scc1 L_b2s_33
    s_add_u32 s86, s8, 26624
    buffer_load_dwordx4 v[232:235], v2, s[64:67], s86 offen sc1
    s_add_u32 s86, s8, 27648
    buffer_load_dwordx4 v[236:239], v2, s[64:67], s86 offen sc1
L_b2s_33:
    s_cmp_eq_u32 s76, 7
    s_cbranch_scc1 L_b2s_34
    s_add_u32 s86, s8, 28672
    buffer_load_dwordx4 v[240:243], v2, s[64:67], s86 offen sc1
    s_add_u32 s86, s8, 29696
    buffer_load_dwordx4 v[244:247], v2, s[64:67], s86 offen sc1
L_b2s_34:
    s_cmp_eq_u32 s76, 7
    s_cbranch_scc1 L_b2s_35
    s_add_u32 s86, s8, 30720
    buffer_load_dwordx4 v[248:251], v2, s[64:67], s86 offen sc1
    s_add_u32 s86, s8, 31744
    buffer_load_dwordx4 v[252:255], v2, s[64:67], s86 offen sc1
L_b2s_35:
    s_cmp_lg_u32 s78, 0
    s_cbranch_scc1 L_cg_36
    s_cmp_eq_u32 s76, 2
    s_cbranch_scc1 L_p1_37
    s_add_u32 m0, s12, 0
    s_add_u32 s86, s8, 32768
    buffer_load_dwordx4 v2, s[64:67], s86 offen sc1 lds
    s_add_u32 m0, s12, 1024
    s_add_u32 s86, s8, 33792
    buffer_load_dwordx4 v2, s[64:67], s86 offen sc1 lds
    s_add_u32 m0, s12, 2048
    s_add_u32 s86, s8, 34816
    buffer_load_dwordx4 v2, s[64:67], s86 offen sc1 lds
    s_add_u32 m0, s12, 3072
    s_add_u32 s86, s8, 35840
    buffer_load_dwordx4 v2, s[64:67], s86 offen sc1 lds
    s_add_u32 m0, s12, 4096
    s_add_u32 s86, s8, 36864
    buffer_load_dwordx4 v2, s[64:67], s86 offen sc1 lds
    s_add_u32 m0, s12, 5120
    s_add_u32 s86, s8, 37888
    buffer_load_dwordx4 v2, s[64:67], s86 offen sc1 lds
    s_add_u32 m0, s12, 6144
    s_add_u32 s86, s8, 38912
    buffer_load_dwordx4 v2, s[64:67], s86 offen sc1 lds
    s_add_u32 m0, s12, 7168
    s_add_u32 s86, s8, 39936
    buffer_load_dwordx4 v2, s[64:67], s86 offen sc1 lds
    s_add_u32 m0, s12, 8192
    s_add_u32 s86, s8, 40960
    buffer_load_dwordx4 v2, s[64:67], s86 offen sc1 lds
    s_add_u32 m0, s12, 9216
    s_add_u32 s86, s8, 41984
    buffer_load_dwordx4 v2, s[64:67], s86 offen sc1 lds
    s_add_u32 m0, s12, 10240
    s_add_u32 s86, s8, 43008
    buffer_load_dwordx4 v2, s[64:67], s86 offen sc1 lds
    s_add_u32 m0, s12, 11264
    s_add_u32 s86, s8, 44032
    buffer_load_dwordx4 v2, s[64:67], s86 offen sc1 lds
    s_add_u32 m0, s12, 12288
    s_add_u32 s86, s8, 45056
    buffer_load_dwordx4 v2, s[64:67], s86 offen sc1 lds
    s_add_u32 m0, s12, 13312
    s_add_u32 s86, s8, 46080
    buffer_load_dwordx4 v2, s[64:67], s86 offen sc1 lds
    s_add_u32 m0, s12, 14336
    s_add_u32 s86, s8, 47104
    buffer_load_dwordx4 v2, s[64:67], s86 offen sc1 lds
    s_add_u32 m0, s12, 15360
    s_add_u32 s86, s8, 48128
    buffer_load_dwordx4 v2, s[64:67], s86 offen sc1 lds
    s_add_u32 m0, s12, 16384
    s_add_u32 s86, s8, 49152
    buffer_load_dwordx4 v2, s[64:67], s86 offen sc1 lds
    s_add_u32 m0, s12, 17408
    s_add_u32 s86, s8, 50176
    buffer_load_dwordx4 v2, s[64:67], s86 offen sc1 lds
    s_add_u32 m0, s12, 18432
    s_add_u32 s86, s8, 51200
    buffer_load_dwordx4 v2, s[64:67], s86 offen sc1 lds
    s_add_u32 m0, s12, 19456
    s_add_u32 s86, s8, 52224
    buffer_load_dwordx4 v2, s[64:67], s86 offen sc1 lds
    s_add_u32 m0, s12, 20480
    s_add_u32 s86, s8, 53248
    buffer_load_dwordx4 v2, s[64:67], s86 offen sc1 lds
    s_add_u32 m0, s12, 21504
    s_add_u32 s86, s8, 54272
    buffer_load_dwordx4 v2, s[64:67], s86 offen sc1 lds
    s_add_u32 m0, s12, 22528
    s_add_u32 s86, s8, 55296
    buffer_load_dwordx4 v2, s[64:67], s86 offen sc1 lds
    s_add_u32 m0, s12, 23552
    s_add_u32 s86, s8, 56320
    buffer_load_dwordx4 v2, s[64:67], s86 offen sc1 lds
L_p1_37:
L_cg_36:
    s_nop 0
    s_mul_i32 s85, s81, 7
    s_add_u32 s85, s85, s84
    s_lshl_b32 s85, s85, 7
    s_add_u32 s6, s85, 16384
    s_mul_i32 s86, s76, 7
    s_lshr_b32 s86, s86, 1
    s_sub_u32 s87, s76, 4
    s_lshl_b32 s87, s87, 2
    s_cmp_lt_u32 s76, 4
    s_cselect_b32 s86, s86, s87
    v_min_u32 v10, 3, v0
    v_add_u32 v10, s86, v10
    v_min_u32 v10, 13, v10
    v_lshlrev_b32 v10, 3, v10
    v_add_u32 v10, s6, v10
    v_and_b32 v11, 3, v0
    v_lshlrev_b32 v11, 3, v11
    s_lshl_b32 s87, s81, 7
    s_add_u32 s87, s87, 12288
    v_add_u32 v11, s87, v11
    v_cmp_gt_u32 vcc, 4, v0
    s_nop 1
    v_cndmask_b32 v10, v11, v10, vcc
    s_mov_b32 s6, 0
    buffer_load_dwordx2 v[12:13], v10, s[64:67], s6 offen sc1
    s_lshl_b32 s11, s81, 1
    s_mul_i32 s11, s11, 172032
    s_mul_i32 s86, s76, 28
    s_sub_u32 s87, s76, 4
    s_lshl_b32 s87, s87, 4
    s_add_u32 s87, s87, 112
    s_cmp_lt_u32 s76, 4
    s_cselect_b32 s86, s86, s87
    s_lshl_b32 s86, s86, 10
    s_add_u32 s11, s11, s86
    s_add_u32 s11, s11, 4194304
    v_add_u32 v4, s12, v2
    s_waitcnt vmcnt(0)
    s_mov_b32 s94, 0
L_p2_38:
    v_xor_b32 v12, s82, v12
    v_xor_b32 v13, s83, v13
    v_or_b32 v12, v12, v13
    v_cmp_ne_u32 vcc, 0, v12
    s_cbranch_vccz L_p2d_39
    s_sleep 1
    buffer_load_dwordx2 v[12:13], v10, s[64:67], s6 offen sc1
    s_waitcnt vmcnt(0)
    s_add_u32 s94, s94, 1
    s_cmp_lt_u32 s94, 50000
    s_cbranch_scc1 L_p2_38
L_p2d_39:
    s_cmp_ge_u32 s76, 4
    s_cbranch_scc1 L_ssm_40
    s_add_u32 s85, s11, 0
    buffer_load_dwordx4 v[16:19], v2, s[64:67], s85 offen sc1
    s_add_u32 s85, s11, 172032
    buffer_load_dwordx4 v[20:23], v2, s[64:67], s85 offen sc1
    s_add_u32 s85, s11, 1024
    buffer_load_dwordx4 v[24:27], v2, s[64:67], s85 offen sc1
    s_add_u32 s85, s11, 173056
    buffer_load_dwordx4 v[28:31], v2, s[64:67], s85 offen sc1
    s_add_u32 s85, s11, 2048
    buffer_load_dwordx4 v[32:35], v2, s[64:67], s85 offen sc1
    s_add_u32 s85, s11, 174080
    buffer_load_dwordx4 v[36:39], v2, s[64:67], s85 offen sc1
    s_add_u32 s85, s11, 3072
    buffer_load_dwordx4 v[40:43], v2, s[64:67], s85 offen sc1
    s_add_u32 s85, s11, 175104
    buffer_load_dwordx4 v[44:47], v2, s[64:67], s85 offen sc1
    s_add_u32 s85, s11, 4096
    buffer_load_dwordx4 v[48:51], v2, s[64:67], s85 offen sc1
    s_add_u32 s85, s11, 176128
    buffer_load_dwordx4 v[52:55], v2, s[64:67], s85 offen sc1
    s_add_u32 s85, s11, 5120
    buffer_load_dwordx4 v[56:59], v2, s[64:67], s85 offen sc1
    s_add_u32 s85, s11, 177152
    buffer_load_dwordx4 v[60:63], v2, s[64:67], s85 offen sc1
    s_waitcnt vmcnt(10)
    v_mfma_f32_32x32x16_bf16 v[64:79], v[16:19], v[128:131], 0
    v_mfma_f32_32x32x16_bf16 v[80:95], v[16:19], v[132:135], 0
    v_mfma_f32_32x32x16_bf16 v[96:111], v[20:23], v[128:131], 0
    v_mfma_f32_32x32x16_bf16 v[112:127], v[20:23], v[132:135], 0
    s_add_u32 s85, s11, 6144
    buffer_load_dwordx4 v[16:19], v2, s[64:67], s85 offen sc1
    s_add_u32 s85, s11, 178176
    buffer_load_dwordx4 v[20:23], v2, s[64:67], s85 offen sc1
    s_waitcnt vmcnt(10)
    v_mfma_f32_32x32x16_bf16 v[64:79], v[24:27], v[136:139], v[64:79]
    v_mfma_f32_32x32x16_bf16 v[80:95], v[24:27], v[140:143], v[80:95]
    v_mfma_f32_32x32x16_bf16 v[96:111], v[28:31], v[136:139], v[96:111]
    v_mfma_f32_32x32x16_bf16 v[112:127], v[28:31], v[140:143], v[112:127]
    s_add_u32 s85, s11, 7168
    buffer_load_dwordx4 v[24:27], v2, s[64:67], s85 offen sc1
    s_add_u32 s85, s11, 179200
    buffer_load_dwordx4 v[28:31], v2, s[64:67], s85 offen sc1
    s_waitcnt vmcnt(10)
    v_mfma_f32_32x32x16_bf16 v[64:79], v[32:35], v[144:147], v[64:79]
    v_mfma_f32_32x32x16_bf16 v[80:95], v[32:35], v[148:151], v[80:95]
    v_mfma_f32_32x32x16_bf16 v[96:111], v[36:39], v[144:147], v[96:111]
    v_mfma_f32_32x32x16_bf16 v[112:127], v[36:39], v[148:151], v[112:127]
    s_add_u32 s85, s11, 8192
    buffer_load_dwordx4 v[32:35], v2, s[64:67], s85 offen sc1
    s_add_u32 s85, s11, 180224
    buffer_load_dwordx4 v[36:39], v2, s[64:67], s85 offen sc1
    s_waitcnt vmcnt(10)
    v_mfma_f32_32x32x16_bf16 v[64:79], v[40:43], v[152:155], v[64:79]
    v_mfma_f32_32x32x16_bf16 v[80:95], v[40:43], v[156:159], v[80:95]
    v_mfma_f32_32x32x16_bf16 v[96:111], v[44:47], v[152:155], v[96:111]
    v_mfma_f32_32x32x16_bf16 v[112:127], v[44:47], v[156:159], v[112:127]
    s_add_u32 s85, s11, 9216
    buffer_load_dwordx4 v[40:43], v2, s[64:67], s85 offen sc1
    s_add_u32 s85, s11, 181248
    buffer_load_dwordx4 v[44:47], v2, s[64:67], s85 offen sc1
    s_waitcnt vmcnt(10)
    v_mfma_f32_32x32x16_bf16 v[64:79], v[48:51], v[160:163], v[64:79]
    v_mfma_f32_32x32x16_bf16 v[80:95], v[48:51], v[164:167], v[80:95]
    v_mfma_f32_32x32x16_bf16 v[96:111], v[52:55], v[160:163], v[96:111]
    v_mfma_f32_32x32x16_bf16 v[112:127], v[52:55], v[164:167], v[112:127]
    s_add_u32 s85, s11, 10240
    buffer_load_dwordx4 v[48:51], v2, s[64:67], s85 offen sc1
    s_add_u32 s85, s11, 182272
    buffer_load_dwordx4 v[52:55], v2, s[64:67], s85 offen sc1
    s_waitcnt vmcnt(10)
    v_mfma_f32_32x32x16_bf16 v[64:79], v[56:59], v[168:171], v[64:79]
    v_mfma_f32_32x32x16_bf16 v[80:95], v[56:59], v[172:175], v[80:95]
    v_mfma_f32_32x32x16_bf16 v[96:111], v[60:63], v[168:171], v[96:111]
    v_mfma_f32_32x32x16_bf16 v[112:127], v[60:63], v[172:175], v[112:127]
    s_add_u32 s85, s11, 11264
    buffer_load_dwordx4 v[56:59], v2, s[64:67], s85 offen sc1
    s_add_u32 s85, s11, 183296
    buffer_load_dwordx4 v[60:63], v2, s[64:67], s85 offen sc1
    s_waitcnt vmcnt(10)
    v_mfma_f32_32x32x16_bf16 v[64:79], v[16:19], v[176:179], v[64:79]
    v_mfma_f32_32x32x16_bf16 v[80:95], v[16:19], v[180:183], v[80:95]
    v_mfma_f32_32x32x16_bf16 v[96:111], v[20:23], v[176:179], v[96:111]
    v_mfma_f32_32x32x16_bf16 v[112:127], v[20:23], v[180:183], v[112:127]
    s_add_u32 s85, s11, 12288
    buffer_load_dwordx4 v[16:19], v2, s[64:67], s85 offen sc1
    s_add_u32 s85, s11, 184320
    buffer_load_dwordx4 v[20:23], v2, s[64:67], s85 offen sc1
    s_waitcnt vmcnt(10)
    v_mfma_f32_32x32x16_bf16 v[64:79], v[24:27], v[184:187], v[64:79]
    v_mfma_f32_32x32x16_bf16 v[80:95], v[24:27], v[188:191], v[80:95]
    v_mfma_f32_32x32x16_bf16 v[96:111], v[28:31], v[184:187], v[96:111]
    v_mfma_f32_32x32x16_bf16 v[112:127], v[28:31], v[188:191], v[112:127]
    s_add_u32 s85, s11, 13312
    buffer_load_dwordx4 v[24:27], v2, s[64:67], s85 offen sc1
    s_add_u32 s85, s11, 185344
    buffer_load_dwordx4 v[28:31], v2, s[64:67], s85 offen sc1
    s_waitcnt vmcnt(10)
    v_mfma_f32_32x32x16_bf16 v[64:79], v[32:35], v[192:195], v[64:79]
    v_mfma_f32_32x32x16_bf16 v[80:95], v[32:35], v[196:199], v[80:95]
    v_mfma_f32_32x32x16_bf16 v[96:111], v[36:39], v[192:195], v[96:111]
    v_mfma_f32_32x32x16_bf16 v[112:127], v[36:39], v[196:199], v[112:127]
    s_add_u32 s85, s11, 14336
    buffer_load_dwordx4 v[32:35], v2, s[64:67], s85 offen sc1
    s_add_u32 s85, s11, 186368
    buffer_load_dwordx4 v[36:39], v2, s[64:67], s85 offen sc1
    s_waitcnt vmcnt(10)
    v_mfma_f32_32x32x16_bf16 v[64:79], v[40:43], v[200:203], v[64:79]
    v_mfma_f32_32x32x16_bf16 v[80:95], v[40:43], v[204:207], v[80:95]
    v_mfma_f32_32x32x16_bf16 v[96:111], v[44:47], v[200:203], v[96:111]
    v_mfma_f32_32x32x16_bf16 v[112:127], v[44:47], v[204:207], v[112:127]
    s_add_u32 s85, s11, 15360
    buffer_load_dwordx4 v[40:43], v2, s[64:67], s85 offen sc1
    s_add_u32 s85, s11, 187392
    buffer_load_dwordx4 v[44:47], v2, s[64:67], s85 offen sc1
    s_waitcnt vmcnt(10)
    v_mfma_f32_32x32x16_bf16 v[64:79], v[48:51], v[208:211], v[64:79]
    v_mfma_f32_32x32x16_bf16 v[80:95], v[48:51], v[212:215], v[80:95]
    v_mfma_f32_32x32x16_bf16 v[96:111], v[52:55], v[208:211], v[96:111]
    v_mfma_f32_32x32x16_bf16 v[112:127], v[52:55], v[212:215], v[112:127]
    s_add_u32 s85, s11, 16384
    buffer_load_dwordx4 v[48:51], v2, s[64:67], s85 offen sc1
    s_add_u32 s85, s11, 188416
    buffer_load_dwordx4 v[52:55], v2, s[64:67], s85 offen sc1
    s_waitcnt vmcnt(10)
    v_mfma_f32_32x32x16_bf16 v[64:79], v[56:59], v[216:219], v[64:79]
    v_mfma_f32_32x32x16_bf16 v[80:95], v[56:59], v[220:223], v[80:95]
    v_mfma_f32_32x32x16_bf16 v[96:111], v[60:63], v[216:219], v[96:111]
    v_mfma_f32_32x32x16_bf16 v[112:127], v[60:63], v[220:223], v[112:127]
    s_add_u32 s85, s11, 17408
    buffer_load_dwordx4 v[56:59], v2, s[64:67], s85 offen sc1
    s_add_u32 s85, s11, 189440
    buffer_load_dwordx4 v[60:63], v2, s[64:67], s85 offen sc1
    s_waitcnt vmcnt(10)
    v_mfma_f32_32x32x16_bf16 v[64:79], v[16:19], v[224:227], v[64:79]
    v_mfma_f32_32x32x16_bf16 v[80:95], v[16:19], v[228:231], v[80:95]
    v_mfma_f32_32x32x16_bf16 v[96:111], v[20:23], v[224:227], v[96:111]
    v_mfma_f32_32x32x16_bf16 v[112:127], v[20:23], v[228:231], v[112:127]
    s_add_u32 s85, s11, 18432
    buffer_load_dwordx4 v[16:19], v2, s[64:67], s85 offen sc1
    s_add_u32 s85, s11, 190464
    buffer_load_dwordx4 v[20:23], v2, s[64:67], s85 offen sc1
    s_waitcnt vmcnt(10)
    v_mfma_f32_32x32x16_bf16 v[64:79], v[24:27], v[232:235], v[64:79]
    v_mfma_f32_32x32x16_bf16 v[80:95], v[24:27], v[236:239], v[80:95]
    v_mfma_f32_32x32x16_bf16 v[96:111], v[28:31], v[232:235], v[96:111]
    v_mfma_f32_32x32x16_bf16 v[112:127], v[28:31], v[236:239], v[112:127]
    s_add_u32 s85, s11, 19456
    buffer_load_dwordx4 v[24:27], v2, s[64:67], s85 offen sc1
    s_add_u32 s85, s11, 191488
    buffer_load_dwordx4 v[28:31], v2, s[64:67], s85 offen sc1
    s_waitcnt vmcnt(10)
    v_mfma_f32_32x32x16_bf16 v[64:79], v[32:35], v[240:243], v[64:79]
    v_mfma_f32_32x32x16_bf16 v[80:95], v[32:35], v[244:247], v[80:95]
    v_mfma_f32_32x32x16_bf16 v[96:111], v[36:39], v[240:243], v[96:111]
    v_mfma_f32_32x32x16_bf16 v[112:127], v[36:39], v[244:247], v[112:127]
    s_add_u32 s85, s11, 20480
    buffer_load_dwordx4 v[32:35], v2, s[64:67], s85 offen sc1
    s_add_u32 s85, s11, 192512
    buffer_load_dwordx4 v[36:39], v2, s[64:67], s85 offen sc1
    ds_read_b128 v[128:131], v4 offset:0
    ds_read_b128 v[132:135], v4 offset:1024
    s_waitcnt vmcnt(10)
    v_mfma_f32_32x32x16_bf16 v[64:79], v[40:43], v[248:251], v[64:79]
    v_mfma_f32_32x32x16_bf16 v[80:95], v[40:43], v[252:255], v[80:95]
    v_mfma_f32_32x32x16_bf16 v[96:111], v[44:47], v[248:251], v[96:111]
    v_mfma_f32_32x32x16_bf16 v[112:127], v[44:47], v[252:255], v[112:127]
    s_add_u32 s85, s11, 21504
    buffer_load_dwordx4 v[40:43], v2, s[64:67], s85 offen sc1
    s_add_u32 s85, s11, 193536
    buffer_load_dwordx4 v[44:47], v2, s[64:67], s85 offen sc1
    s_waitcnt vmcnt(10)
    ds_read_b128 v[136:139], v4 offset:2048
    ds_read_b128 v[140:143], v4 offset:3072
    s_waitcnt lgkmcnt(2)
    v_mfma_f32_32x32x16_bf16 v[64:79], v[48:51], v[128:131], v[64:79]
    v_mfma_f32_32x32x16_bf16 v[80:95], v[48:51], v[132:135], v[80:95]
    v_mfma_f32_32x32x16_bf16 v[96:111], v[52:55], v[128:131], v[96:111]
    v_mfma_f32_32x32x16_bf16 v[112:127], v[52:55], v[132:135], v[112:127]
    s_add_u32 s85, s11, 22528
    buffer_load_dwordx4 v[48:51], v2, s[64:67], s85 offen sc1
    s_add_u32 s85, s11, 194560
    buffer_load_dwordx4 v[52:55], v2, s[64:67], s85 offen sc1
    s_waitcnt vmcnt(10)
    ds_read_b128 v[128:131], v4 offset:4096
    ds_read_b128 v[132:135], v4 offset:5120
    s_waitcnt lgkmcnt(2)
    v_mfma_f32_32x32x16_bf16 v[64:79], v[56:59], v[136:139], v[64:79]
    v_mfma_f32_32x32x16_bf16 v[80:95], v[56:59], v[140:143], v[80:95]
    v_mfma_f32_32x32x16_bf16 v[96:111], v[60:63], v[136:139], v[96:111]
    v_mfma_f32_32x32x16_bf16 v[112:127], v[60:63], v[140:143], v[112:127]
    s_add_u32 s85, s11, 23552
    buffer_load_dwordx4 v[56:59], v2, s[64:67], s85 offen sc1
    s_add_u32 s85, s11, 195584
    buffer_load_dwordx4 v[60:63], v2, s[64:67], s85 offen sc1
    s_waitcnt vmcnt(10)
    ds_read_b128 v[136:139], v4 offset:6144
    ds_read_b128 v[140:143], v4 offset:7168
    s_waitcnt lgkmcnt(2)
    v_mfma_f32_32x32x16_bf16 v[64:79], v[16:19], v[128:131], v[64:79]
    v_mfma_f32_32x32x16_bf16 v[80:95], v[16:19], v[132:135], v[80:95]
    v_mfma_f32_32x32x16_bf16 v[96:111], v[20:23], v[128:131], v[96:111]
    v_mfma_f32_32x32x16_bf16 v[112:127], v[20:23], v[132:135], v[112:127]
    s_add_u32 s85, s11, 24576
    buffer_load_dwordx4 v[16:19], v2, s[64:67], s85 offen sc1
    s_add_u32 s85, s11, 196608
    buffer_load_dwordx4 v[20:23], v2, s[64:67], s85 offen sc1
    s_waitcnt vmcnt(10)
    ds_read_b128 v[128:131], v4 offset:8192
    ds_read_b128 v[132:135], v4 offset:9216
    s_waitcnt lgkmcnt(2)
    v_mfma_f32_32x32x16_bf16 v[64:79], v[24:27], v[136:139], v[64:79]
    v_mfma_f32_32x32x16_bf16 v[80:95], v[24:27], v[140:143], v[80:95]
    v_mfma_f32_32x32x16_bf16 v[96:111], v[28:31], v[136:139], v[96:111]
    v_mfma_f32_32x32x16_bf16 v[112:127], v[28:31], v[140:143], v[112:127]
    s_add_u32 s85, s11, 25600
    buffer_load_dwordx4 v[24:27], v2, s[64:67], s85 offen sc1
    s_add_u32 s85, s11, 197632
    buffer_load_dwordx4 v[28:31], v2, s[64:67], s85 offen sc1
    s_waitcnt vmcnt(10)
    ds_read_b128 v[136:139], v4 offset:10240
    ds_read_b128 v[140:143], v4 offset:11264
    s_waitcnt lgkmcnt(2)
    v_mfma_f32_32x32x16_bf16 v[64:79], v[32:35], v[128:131], v[64:79]
    v_mfma_f32_32x32x16_bf16 v[80:95], v[32:35], v[132:135], v[80:95]
    v_mfma_f32_32x32x16_bf16 v[96:111], v[36:39], v[128:131], v[96:111]
    v_mfma_f32_32x32x16_bf16 v[112:127], v[36:39], v[132:135], v[112:127]
    s_add_u32 s85, s11, 26624
    buffer_load_dwordx4 v[32:35], v2, s[64:67], s85 offen sc1
    s_add_u32 s85, s11, 198656
    buffer_load_dwordx4 v[36:39], v2, s[64:67], s85 offen sc1
    s_waitcnt vmcnt(10)
    ds_read_b128 v[128:131], v4 offset:12288
    ds_read_b128 v[132:135], v4 offset:13312
    s_waitcnt lgkmcnt(2)
    v_mfma_f32_32x32x16_bf16 v[64:79], v[40:43], v[136:139], v[64:79]
    v_mfma_f32_32x32x16_bf16 v[80:95], v[40:43], v[140:143], v[80:95]
    v_mfma_f32_32x32x16_bf16 v[96:111], v[44:47], v[136:139], v[96:111]
    v_mfma_f32_32x32x16_bf16 v[112:127], v[44:47], v[140:143], v[112:127]
    s_add_u32 s85, s11, 27648
    buffer_load_dwordx4 v[40:43], v2, s[64:67], s85 offen sc1
    s_add_u32 s85, s11, 199680
    buffer_load_dwordx4 v[44:47], v2, s[64:67], s85 offen sc1
    s_waitcnt vmcnt(10)
    ds_read_b128 v[136:139], v4 offset:14336
    ds_read_b128 v[140:143], v4 offset:15360
    s_waitcnt lgkmcnt(2)
    v_mfma_f32_32x32x16_bf16 v[64:79], v[48:51], v[128:131], v[64:79]
    v_mfma_f32_32x32x16_bf16 v[80:95], v[48:51], v[132:135], v[80:95]
    v_mfma_f32_32x32x16_bf16 v[96:111], v[52:55], v[128:131], v[96:111]
    v_mfma_f32_32x32x16_bf16 v[112:127], v[52:55], v[132:135], v[112:127]
    s_mov_b32 s52, s42
    s_mov_b32 s53, s43
    s_mov_b32 s54, 3670016
    s_mov_b32 s55, 0x00020000
    s_lshr_b32 s85, s76, 2
    s_lshr_b32 s86, s76, 1
    s_and_b32 s86, s86, 1
    s_and_b32 s87, s76, 1
    s_lshl_b32 s88, s81, 6
    s_lshl_b32 s85, s85, 5
    s_add_u32 s88, s88, s85
    s_lshl_b32 s87, s87, 3
    s_add_u32 s88, s88, s87
    s_lshl_b32 s89, s84, 6
    s_lshl_b32 s86, s86, 5
    s_add_u32 s89, s89, s86
    v_and_b32 v9, 31, v0
    v_lshrrev_b32 v10, 5, v0
    v_mul_u32_u24 v11, 14336, v10
    v_lshlrev_b32 v12, 1, v9
    v_add_u32 v11, v11, v12
    s_mul_i32 s85, s88, 896
    s_lshl_b32 s86, s89, 1
    s_add_u32 s85, s85, s86
    s_add_u32 s86, s85, 3584
    buffer_load_ushort v192, v11, s[48:51], s85 offen offset:0
    buffer_load_ushort v193, v11, s[48:51], s85 offen offset:896
    buffer_load_ushort v194, v11, s[48:51], s85 offen offset:1792
    buffer_load_ushort v195, v11, s[48:51], s85 offen offset:2688
    buffer_load_ushort v196, v11, s[48:51], s86 offen offset:0
    buffer_load_ushort v197, v11, s[48:51], s86 offen offset:896
    buffer_load_ushort v198, v11, s[48:51], s86 offen offset:1792
    buffer_load_ushort v199, v11, s[48:51], s86 offen offset:2688
    v_add_u32 v12, s89, v9
    v_lshlrev_b32 v12, 1, v12
    global_load_ushort v5, v12, s[32:33]
    v_mul_u32_u24 v13, 28672, v10
    v_lshlrev_b32 v12, 2, v9
    v_add_u32 v13, v13, v12
    s_mul_i32 s4, s88, 1792
    s_lshl_b32 s85, s89, 2
    s_add_u32 s4, s4, s85
    v_lshlrev_b32 v12, 7, v10
    s_lshl_b32 s5, s88, 3
    s_add_u32 s5, s5, 229376
    buffer_load_dwordx4 v[200:203], v12, s[64:67], s5 offen offset:0 sc1
    buffer_load_dwordx4 v[204:207], v12, s[64:67], s5 offen offset:16 sc1
    buffer_load_dwordx4 v[208:211], v12, s[64:67], s5 offen offset:32 sc1
    buffer_load_dwordx4 v[212:215], v12, s[64:67], s5 offen offset:48 sc1
    s_mov_b32 s85, 0
    s_mov_b32 s86, 8192
    s_cmp_eq_u32 s76, 1
    s_cselect_b32 s85, 32768, s85
    s_cselect_b32 s86, 40960, s86
    s_cmp_eq_u32 s76, 2
    s_cselect_b32 s85, 131072, s85
    s_cselect_b32 s86, 139264, s86
    s_cmp_eq_u32 s76, 3
    s_cselect_b32 s85, 106496, s85
    s_cselect_b32 s86, 114688, s86
    s_cmp_eq_u32 s76, 4
    s_cselect_b32 s85, 65536, s85
    s_cselect_b32 s86, 73728, s86
    s_cmp_eq_u32 s76, 5
    s_cselect_b32 s85, 81920, s85
    s_cselect_b32 s86, 90112, s86
    s_cmp_eq_u32 s76, 6
    s_cselect_b32 s85, 24576, s85
    s_cselect_b32 s86, 57344, s86
    s_cmp_eq_u32 s76, 7
    s_cselect_b32 s85, 155648, s85
    s_cselect_b32 s86, 98304, s86
    v_add_u32 v6, s85, v2
    v_add_u32 v7, s86, v2
    s_waitcnt vmcnt(21)
    ds_read_b128 v[128:131], v4 offset:16384
    ds_read_b128 v[132:135], v4 offset:17408
    s_waitcnt lgkmcnt(2)
    v_mfma_f32_32x32x16_bf16 v[64:79], v[56:59], v[136:139], v[64:79]
    v_mfma_f32_32x32x16_bf16 v[80:95], v[56:59], v[140:143], v[80:95]
    v_mfma_f32_32x32x16_bf16 v[96:111], v[60:63], v[136:139], v[96:111]
    v_mfma_f32_32x32x16_bf16 v[112:127], v[60:63], v[140:143], v[112:127]
    s_waitcnt vmcnt(19)
    ds_read_b128 v[136:139], v4 offset:18432
    ds_read_b128 v[140:143], v4 offset:19456
    s_waitcnt lgkmcnt(2)
    v_mfma_f32_32x32x16_bf16 v[64:79], v[16:19], v[128:131], v[64:79]
    v_mfma_f32_32x32x16_bf16 v[80:95], v[16:19], v[132:135], v[80:95]
    v_mfma_f32_32x32x16_bf16 v[96:111], v[20:23], v[128:131], v[96:111]
    v_mfma_f32_32x32x16_bf16 v[112:127], v[20:23], v[132:135], v[112:127]
    s_waitcnt vmcnt(17)
    ds_read_b128 v[128:131], v4 offset:20480
    ds_read_b128 v[132:135], v4 offset:21504
    s_waitcnt lgkmcnt(2)
    v_mfma_f32_32x32x16_bf16 v[64:79], v[24:27], v[136:139], v[64:79]
    v_mfma_f32_32x32x16_bf16 v[80:95], v[24:27], v[140:143], v[80:95]
    v_mfma_f32_32x32x16_bf16 v[96:111], v[28:31], v[136:139], v[96:111]
    v_mfma_f32_32x32x16_bf16 v[112:127], v[28:31], v[140:143], v[112:127]
    s_waitcnt vmcnt(15)
    ds_read_b128 v[136:139], v4 offset:22528
    ds_read_b128 v[140:143], v4 offset:23552
    s_waitcnt lgkmcnt(2)
    v_mfma_f32_32x32x16_bf16 v[64:79], v[32:35], v[128:131], v[64:79]
    v_mfma_f32_32x32x16_bf16 v[80:95], v[32:35], v[132:135], v[80:95]
    v_mfma_f32_32x32x16_bf16 v[96:111], v[36:39], v[128:131], v[96:111]
    v_mfma_f32_32x32x16_bf16 v[112:127], v[36:39], v[132:135], v[112:127]
    s_waitcnt vmcnt(13)
    s_waitcnt lgkmcnt(0)
    v_mfma_f32_32x32x16_bf16 v[64:79], v[40:43], v[136:139], v[64:79]
    v_mfma_f32_32x32x16_bf16 v[80:95], v[40:43], v[140:143], v[80:95]
    v_mfma_f32_32x32x16_bf16 v[96:111], v[44:47], v[136:139], v[96:111]
    v_mfma_f32_32x32x16_bf16 v[112:127], v[44:47], v[140:143], v[112:127]
    s_branch L_p2j_42
L_ssm_40:
    s_cmp_eq_u32 s76, 7
    s_cbranch_scc1 L_w7_41
    s_add_u32 s85, s11, 0
    buffer_load_dwordx4 v[16:19], v2, s[64:67], s85 offen sc1
    s_add_u32 s85, s11, 172032
    buffer_load_dwordx4 v[20:23], v2, s[64:67], s85 offen sc1
    s_add_u32 s85, s11, 1024
    buffer_load_dwordx4 v[24:27], v2, s[64:67], s85 offen sc1
    s_add_u32 s85, s11, 173056
    buffer_load_dwordx4 v[28:31], v2, s[64:67], s85 offen sc1
    s_add_u32 s85, s11, 2048
    buffer_load_dwordx4 v[32:35], v2, s[64:67], s85 offen sc1
    s_add_u32 s85, s11, 174080
    buffer_load_dwordx4 v[36:39], v2, s[64:67], s85 offen sc1
    s_add_u32 s85, s11, 3072
    buffer_load_dwordx4 v[40:43], v2, s[64:67], s85 offen sc1
    s_add_u32 s85, s11, 175104
    buffer_load_dwordx4 v[44:47], v2, s[64:67], s85 offen sc1
    s_add_u32 s85, s11, 4096
    buffer_load_dwordx4 v[48:51], v2, s[64:67], s85 offen sc1
    s_add_u32 s85, s11, 176128
    buffer_load_dwordx4 v[52:55], v2, s[64:67], s85 offen sc1
    s_add_u32 s85, s11, 5120
    buffer_load_dwordx4 v[56:59], v2, s[64:67], s85 offen sc1
    s_add_u32 s85, s11, 177152
    buffer_load_dwordx4 v[60:63], v2, s[64:67], s85 offen sc1
    s_waitcnt vmcnt(10)
    v_mfma_f32_32x32x16_bf16 v[64:79], v[16:19], v[128:131], 0
    v_mfma_f32_32x32x16_bf16 v[80:95], v[16:19], v[132:135], 0
    v_mfma_f32_32x32x16_bf16 v[96:111], v[20:23], v[128:131], 0
    v_mfma_f32_32x32x16_bf16 v[112:127], v[20:23], v[132:135], 0
    s_add_u32 s85, s11, 6144
    buffer_load_dwordx4 v[16:19], v2, s[64:67], s85 offen sc1
    s_add_u32 s85, s11, 178176
    buffer_load_dwordx4 v[20:23], v2, s[64:67], s85 offen sc1
    s_waitcnt vmcnt(10)
    v_mfma_f32_32x32x16_bf16 v[64:79], v[24:27], v[136:139], v[64:79]
    v_mfma_f32_32x32x16_bf16 v[80:95], v[24:27], v[140:143], v[80:95]
    v_mfma_f32_32x32x16_bf16 v[96:111], v[28:31], v[136:139], v[96:111]
    v_mfma_f32_32x32x16_bf16 v[112:127], v[28:31], v[140:143], v[112:127]
    s_add_u32 s85, s11, 7168
    buffer_load_dwordx4 v[24:27], v2, s[64:67], s85 offen sc1
    s_add_u32 s85, s11, 179200
    buffer_load_dwordx4 v[28:31], v2, s[64:67], s85 offen sc1
    s_waitcnt vmcnt(10)
    v_mfma_f32_32x32x16_bf16 v[64:79], v[32:35], v[144:147], v[64:79]
    v_mfma_f32_32x32x16_bf16 v[80:95], v[32:35], v[148:151], v[80:95]
    v_mfma_f32_32x32x16_bf16 v[96:111], v[36:39], v[144:147], v[96:111]
    v_mfma_f32_32x32x16_bf16 v[112:127], v[36:39], v[148:151], v[112:127]
    s_add_u32 s85, s11, 8192
    buffer_load_dwordx4 v[32:35], v2, s[64:67], s85 offen sc1
    s_add_u32 s85, s11, 180224
    buffer_load_dwordx4 v[36:39], v2, s[64:67], s85 offen sc1
    s_waitcnt vmcnt(10)
    v_mfma_f32_32x32x16_bf16 v[64:79], v[40:43], v[152:155], v[64:79]
    v_mfma_f32_32x32x16_bf16 v[80:95], v[40:43], v[156:159], v[80:95]
    v_mfma_f32_32x32x16_bf16 v[96:111], v[44:47], v[152:155], v[96:111]
    v_mfma_f32_32x32x16_bf16 v[112:127], v[44:47], v[156:159], v[112:127]
    s_add_u32 s85, s11, 9216
    buffer_load_dwordx4 v[40:43], v2, s[64:67], s85 offen sc1
    s_add_u32 s85, s11, 181248
    buffer_load_dwordx4 v[44:47], v2, s[64:67], s85 offen sc1
    s_waitcnt vmcnt(10)
    v_mfma_f32_32x32x16_bf16 v[64:79], v[48:51], v[160:163], v[64:79]
    v_mfma_f32_32x32x16_bf16 v[80:95], v[48:51], v[164:167], v[80:95]
    v_mfma_f32_32x32x16_bf16 v[96:111], v[52:55], v[160:163], v[96:111]
    v_mfma_f32_32x32x16_bf16 v[112:127], v[52:55], v[164:167], v[112:127]
    s_add_u32 s85, s11, 10240
    buffer_load_dwordx4 v[48:51], v2, s[64:67], s85 offen sc1
    s_add_u32 s85, s11, 182272
    buffer_load_dwordx4 v[52:55], v2, s[64:67], s85 offen sc1
    s_waitcnt vmcnt(10)
    v_mfma_f32_32x32x16_bf16 v[64:79], v[56:59], v[168:171], v[64:79]
    v_mfma_f32_32x32x16_bf16 v[80:95], v[56:59], v[172:175], v[80:95]
    v_mfma_f32_32x32x16_bf16 v[96:111], v[60:63], v[168:171], v[96:111]
    v_mfma_f32_32x32x16_bf16 v[112:127], v[60:63], v[172:175], v[112:127]
    s_add_u32 s85, s11, 11264
    buffer_load_dwordx4 v[56:59], v2, s[64:67], s85 offen sc1
    s_add_u32 s85, s11, 183296
    buffer_load_dwordx4 v[60:63], v2, s[64:67], s85 offen sc1
    s_waitcnt vmcnt(10)
    v_mfma_f32_32x32x16_bf16 v[64:79], v[16:19], v[176:179], v[64:79]
    v_mfma_f32_32x32x16_bf16 v[80:95], v[16:19], v[180:183], v[80:95]
    v_mfma_f32_32x32x16_bf16 v[96:111], v[20:23], v[176:179], v[96:111]
    v_mfma_f32_32x32x16_bf16 v[112:127], v[20:23], v[180:183], v[112:127]
    s_add_u32 s85, s11, 12288
    buffer_load_dwordx4 v[16:19], v2, s[64:67], s85 offen sc1
    s_add_u32 s85, s11, 184320
    buffer_load_dwordx4 v[20:23], v2, s[64:67], s85 offen sc1
    s_waitcnt vmcnt(10)
    v_mfma_f32_32x32x16_bf16 v[64:79], v[24:27], v[184:187], v[64:79]
    v_mfma_f32_32x32x16_bf16 v[80:95], v[24:27], v[188:191], v[80:95]
    v_mfma_f32_32x32x16_bf16 v[96:111], v[28:31], v[184:187], v[96:111]
    v_mfma_f32_32x32x16_bf16 v[112:127], v[28:31], v[188:191], v[112:127]
    s_add_u32 s85, s11, 13312
    buffer_load_dwordx4 v[24:27], v2, s[64:67], s85 offen sc1
    s_add_u32 s85, s11, 185344
    buffer_load_dwordx4 v[28:31], v2, s[64:67], s85 offen sc1
    s_waitcnt vmcnt(10)
    v_mfma_f32_32x32x16_bf16 v[64:79], v[32:35], v[192:195], v[64:79]
    v_mfma_f32_32x32x16_bf16 v[80:95], v[32:35], v[196:199], v[80:95]
    v_mfma_f32_32x32x16_bf16 v[96:111], v[36:39], v[192:195], v[96:111]
    v_mfma_f32_32x32x16_bf16 v[112:127], v[36:39], v[196:199], v[112:127]
    s_add_u32 s85, s11, 14336
    buffer_load_dwordx4 v[32:35], v2, s[64:67], s85 offen sc1
    s_add_u32 s85, s11, 186368
    buffer_load_dwordx4 v[36:39], v2, s[64:67], s85 offen sc1
    s_waitcnt vmcnt(10)
    v_mfma_f32_32x32x16_bf16 v[64:79], v[40:43], v[200:203], v[64:79]
    v_mfma_f32_32x32x16_bf16 v[80:95], v[40:43], v[204:207], v[80:95]
    v_mfma_f32_32x32x16_bf16 v[96:111], v[44:47], v[200:203], v[96:111]
    v_mfma_f32_32x32x16_bf16 v[112:127], v[44:47], v[204:207], v[112:127]
    s_add_u32 s85, s11, 15360
    buffer_load_dwordx4 v[40:43], v2, s[64:67], s85 offen sc1
    s_add_u32 s85, s11, 187392
    buffer_load_dwordx4 v[44:47], v2, s[64:67], s85 offen sc1
    s_waitcnt vmcnt(10)
    v_mfma_f32_32x32x16_bf16 v[64:79], v[48:51], v[208:211], v[64:79]
    v_mfma_f32_32x32x16_bf16 v[80:95], v[48:51], v[212:215], v[80:95]
    v_mfma_f32_32x32x16_bf16 v[96:111], v[52:55], v[208:211], v[96:111]
    v_mfma_f32_32x32x16_bf16 v[112:127], v[52:55], v[212:215], v[112:127]
    s_mov_b32 s52, s42
    s_mov_b32 s53, s43
    s_mov_b32 s54, 3670016
    s_mov_b32 s55, 0x00020000
    s_lshr_b32 s85, s76, 2
    s_lshr_b32 s86, s76, 1
    s_and_b32 s86, s86, 1
    s_and_b32 s87, s76, 1
    s_lshl_b32 s88, s81, 6
    s_lshl_b32 s85, s85, 5
    s_add_u32 s88, s88, s85
    s_lshl_b32 s87, s87, 3
    s_add_u32 s88, s88, s87
    s_lshl_b32 s89, s84, 6
    s_lshl_b32 s86, s86, 5
    s_add_u32 s89, s89, s86
    v_and_b32 v9, 31, v0
    v_lshrrev_b32 v10, 5, v0
    v_mul_u32_u24 v11, 14336, v10
    v_lshlrev_b32 v12, 1, v9
    v_add_u32 v11, v11, v12
    s_mul_i32 s85, s88, 896
    s_lshl_b32 s86, s89, 1
    s_add_u32 s85, s85, s86
    s_add_u32 s86, s85, 3584
    buffer_load_ushort v192, v11, s[48:51], s85 offen offset:0
    buffer_load_ushort v193, v11, s[48:51], s85 offen offset:896
    buffer_load_ushort v194, v11, s[48:51], s85 offen offset:1792
    buffer_load_ushort v195, v11, s[48:51], s85 offen offset:2688
    buffer_load_ushort v196, v11, s[48:51], s86 offen offset:0
    buffer_load_ushort v197, v11, s[48:51], s86 offen offset:896
    buffer_load_ushort v198, v11, s[48:51], s86 offen offset:1792
    buffer_load_ushort v199, v11, s[48:51], s86 offen offset:2688
    v_add_u32 v12, s89, v9
    v_lshlrev_b32 v12, 1, v12
    global_load_ushort v5, v12, s[32:33]
    v_mul_u32_u24 v13, 28672, v10
    v_lshlrev_b32 v12, 2, v9
    v_add_u32 v13, v13, v12
    s_mul_i32 s4, s88, 1792
    s_lshl_b32 s85, s89, 2
    s_add_u32 s4, s4, s85
    v_lshlrev_b32 v12, 7, v10
    s_lshl_b32 s5, s88, 3
    s_add_u32 s5, s5, 229376
    buffer_load_dwordx4 v[200:203], v12, s[64:67], s5 offen offset:0 sc1
    buffer_load_dwordx4 v[204:207], v12, s[64:67], s5 offen offset:16 sc1
    buffer_load_dwordx4 v[208:211], v12, s[64:67], s5 offen offset:32 sc1
    buffer_load_dwordx4 v[212:215], v12, s[64:67], s5 offen offset:48 sc1
    s_mov_b32 s85, 0
    s_mov_b32 s86, 8192
    s_cmp_eq_u32 s76, 1
    s_cselect_b32 s85, 32768, s85
    s_cselect_b32 s86, 40960, s86
    s_cmp_eq_u32 s76, 2
    s_cselect_b32 s85, 131072, s85
    s_cselect_b32 s86, 139264, s86
    s_cmp_eq_u32 s76, 3
    s_cselect_b32 s85, 106496, s85
    s_cselect_b32 s86, 114688, s86
    s_cmp_eq_u32 s76, 4
    s_cselect_b32 s85, 65536, s85
    s_cselect_b32 s86, 73728, s86
    s_cmp_eq_u32 s76, 5
    s_cselect_b32 s85, 81920, s85
    s_cselect_b32 s86, 90112, s86
    s_cmp_eq_u32 s76, 6
    s_cselect_b32 s85, 24576, s85
    s_cselect_b32 s86, 57344, s86
    s_cmp_eq_u32 s76, 7
    s_cselect_b32 s85, 155648, s85
    s_cselect_b32 s86, 98304, s86
    v_add_u32 v6, s85, v2
    v_add_u32 v7, s86, v2
    s_waitcnt vmcnt(21)
    v_mfma_f32_32x32x16_bf16 v[64:79], v[56:59], v[216:219], v[64:79]
    v_mfma_f32_32x32x16_bf16 v[80:95], v[56:59], v[220:223], v[80:95]
    v_mfma_f32_32x32x16_bf16 v[96:111], v[60:63], v[216:219], v[96:111]
    v_mfma_f32_32x32x16_bf16 v[112:127], v[60:63], v[220:223], v[112:127]
    s_waitcnt vmcnt(19)
    v_mfma_f32_32x32x16_bf16 v[64:79], v[16:19], v[224:227], v[64:79]
    v_mfma_f32_32x32x16_bf16 v[80:95], v[16:19], v[228:231], v[80:95]
    v_mfma_f32_32x32x16_bf16 v[96:111], v[20:23], v[224:227], v[96:111]
    v_mfma_f32_32x32x16_bf16 v[112:127], v[20:23], v[228:231], v[112:127]
    s_waitcnt vmcnt(17)
    v_mfma_f32_32x32x16_bf16 v[64:79], v[24:27], v[232:235], v[64:79]
    v_mfma_f32_32x32x16_bf16 v[80:95], v[24:27], v[236:239], v[80:95]
    v_mfma_f32_32x32x16_bf16 v[96:111], v[28:31], v[232:235], v[96:111]
    v_mfma_f32_32x32x16_bf16 v[112:127], v[28:31], v[236:239], v[112:127]
    s_waitcnt vmcnt(15)
    v_mfma_f32_32x32x16_bf16 v[64:79], v[32:35], v[240:243], v[64:79]
    v_mfma_f32_32x32x16_bf16 v[80:95], v[32:35], v[244:247], v[80:95]
    v_mfma_f32_32x32x16_bf16 v[96:111], v[36:39], v[240:243], v[96:111]
    v_mfma_f32_32x32x16_bf16 v[112:127], v[36:39], v[244:247], v[112:127]
    s_waitcnt vmcnt(13)
    v_mfma_f32_32x32x16_bf16 v[64:79], v[40:43], v[248:251], v[64:79]
    v_mfma_f32_32x32x16_bf16 v[80:95], v[40:43], v[252:255], v[80:95]
    v_mfma_f32_32x32x16_bf16 v[96:111], v[44:47], v[248:251], v[96:111]
    v_mfma_f32_32x32x16_bf16 v[112:127], v[44:47], v[252:255], v[112:127]
    s_branch L_p2j_42
L_w7_41:
    s_add_u32 s85, s11, 0
    buffer_load_dwordx4 v[16:19], v2, s[64:67], s85 offen sc1
    s_add_u32 s85, s11, 172032
    buffer_load_dwordx4 v[20:23], v2, s[64:67], s85 offen sc1
    s_add_u32 s85, s11, 1024
    buffer_load_dwordx4 v[24:27], v2, s[64:67], s85 offen sc1
    s_add_u32 s85, s11, 173056
    buffer_load_dwordx4 v[28:31], v2, s[64:67], s85 offen sc1
    s_add_u32 s85, s11, 2048
    buffer_load_dwordx4 v[32:35], v2, s[64:67], s85 offen sc1
    s_add_u32 s85, s11, 174080
    buffer_load_dwordx4 v[36:39], v2, s[64:67], s85 offen sc1
    s_add_u32 s85, s11, 3072
    buffer_load_dwordx4 v[40:43], v2, s[64:67], s85 offen sc1
    s_add_u32 s85, s11, 175104
    buffer_load_dwordx4 v[44:47], v2, s[64:67], s85 offen sc1
    s_add_u32 s85, s11, 4096
    buffer_load_dwordx4 v[48:51], v2, s[64:67], s85 offen sc1
    s_add_u32 s85, s11, 176128
    buffer_load_dwordx4 v[52:55], v2, s[64:67], s85 offen sc1
    s_add_u32 s85, s11, 5120
    buffer_load_dwordx4 v[56:59], v2, s[64:67], s85 offen sc1
    s_add_u32 s85, s11, 177152
    buffer_load_dwordx4 v[60:63], v2, s[64:67], s85 offen sc1
    s_waitcnt vmcnt(10)
    v_mfma_f32_32x32x16_bf16 v[64:79], v[16:19], v[128:131], 0
    v_mfma_f32_32x32x16_bf16 v[80:95], v[16:19], v[132:135], 0
    v_mfma_f32_32x32x16_bf16 v[96:111], v[20:23], v[128:131], 0
    v_mfma_f32_32x32x16_bf16 v[112:127], v[20:23], v[132:135], 0
    s_add_u32 s85, s11, 6144
    buffer_load_dwordx4 v[16:19], v2, s[64:67], s85 offen sc1
    s_add_u32 s85, s11, 178176
    buffer_load_dwordx4 v[20:23], v2, s[64:67], s85 offen sc1
    s_waitcnt vmcnt(10)
    v_mfma_f32_32x32x16_bf16 v[64:79], v[24:27], v[136:139], v[64:79]
    v_mfma_f32_32x32x16_bf16 v[80:95], v[24:27], v[140:143], v[80:95]
    v_mfma_f32_32x32x16_bf16 v[96:111], v[28:31], v[136:139], v[96:111]
    v_mfma_f32_32x32x16_bf16 v[112:127], v[28:31], v[140:143], v[112:127]
    s_add_u32 s85, s11, 7168
    buffer_load_dwordx4 v[24:27], v2, s[64:67], s85 offen sc1
    s_add_u32 s85, s11, 179200
    buffer_load_dwordx4 v[28:31], v2, s[64:67], s85 offen sc1
    s_waitcnt vmcnt(10)
    v_mfma_f32_32x32x16_bf16 v[64:79], v[32:35], v[144:147], v[64:79]
    v_mfma_f32_32x32x16_bf16 v[80:95], v[32:35], v[148:151], v[80:95]
    v_mfma_f32_32x32x16_bf16 v[96:111], v[36:39], v[144:147], v[96:111]
    v_mfma_f32_32x32x16_bf16 v[112:127], v[36:39], v[148:151], v[112:127]
    s_mov_b32 s52, s42
    s_mov_b32 s53, s43
    s_mov_b32 s54, 3670016
    s_mov_b32 s55, 0x00020000
    s_lshr_b32 s85, s76, 2
    s_lshr_b32 s86, s76, 1
    s_and_b32 s86, s86, 1
    s_and_b32 s87, s76, 1
    s_lshl_b32 s88, s81, 6
    s_lshl_b32 s85, s85, 5
    s_add_u32 s88, s88, s85
    s_lshl_b32 s87, s87, 3
    s_add_u32 s88, s88, s87
    s_lshl_b32 s89, s84, 6
    s_lshl_b32 s86, s86, 5
    s_add_u32 s89, s89, s86
    v_and_b32 v9, 31, v0
    v_lshrrev_b32 v10, 5, v0
    v_mul_u32_u24 v11, 14336, v10
    v_lshlrev_b32 v12, 1, v9
    v_add_u32 v11, v11, v12
    s_mul_i32 s85, s88, 896
    s_lshl_b32 s86, s89, 1
    s_add_u32 s85, s85, s86
    s_add_u32 s86, s85, 3584
    buffer_load_ushort v192, v11, s[48:51], s85 offen offset:0
    buffer_load_ushort v193, v11, s[48:51], s85 offen offset:896
    buffer_load_ushort v194, v11, s[48:51], s85 offen offset:1792
    buffer_load_ushort v195, v11, s[48:51], s85 offen offset:2688
    buffer_load_ushort v196, v11, s[48:51], s86 offen offset:0
    buffer_load_ushort v197, v11, s[48:51], s86 offen offset:896
    buffer_load_ushort v198, v11, s[48:51], s86 offen offset:1792
    buffer_load_ushort v199, v11, s[48:51], s86 offen offset:2688
    v_add_u32 v12, s89, v9
    v_lshlrev_b32 v12, 1, v12
    global_load_ushort v5, v12, s[32:33]
    v_mul_u32_u24 v13, 28672, v10
    v_lshlrev_b32 v12, 2, v9
    v_add_u32 v13, v13, v12
    s_mul_i32 s4, s88, 1792
    s_lshl_b32 s85, s89, 2
    s_add_u32 s4, s4, s85
    v_lshlrev_b32 v12, 7, v10
    s_lshl_b32 s5, s88, 3
    s_add_u32 s5, s5, 229376
    buffer_load_dwordx4 v[200:203], v12, s[64:67], s5 offen offset:0 sc1
    buffer_load_dwordx4 v[204:207], v12, s[64:67], s5 offen offset:16 sc1
    buffer_load_dwordx4 v[208:211], v12, s[64:67], s5 offen offset:32 sc1
    buffer_load_dwordx4 v[212:215], v12, s[64:67], s5 offen offset:48 sc1
    s_mov_b32 s85, 0
    s_mov_b32 s86, 8192
    s_cmp_eq_u32 s76, 1
    s_cselect_b32 s85, 32768, s85
    s_cselect_b32 s86, 40960, s86
    s_cmp_eq_u32 s76, 2
    s_cselect_b32 s85, 131072, s85
    s_cselect_b32 s86, 139264, s86
    s_cmp_eq_u32 s76, 3
    s_cselect_b32 s85, 106496, s85
    s_cselect_b32 s86, 114688, s86
    s_cmp_eq_u32 s76, 4
    s_cselect_b32 s85, 65536, s85
    s_cselect_b32 s86, 73728, s86
    s_cmp_eq_u32 s76, 5
    s_cselect_b32 s85, 81920, s85
    s_cselect_b32 s86, 90112, s86
    s_cmp_eq_u32 s76, 6
    s_cselect_b32 s85, 24576, s85
    s_cselect_b32 s86, 57344, s86
    s_cmp_eq_u32 s76, 7
    s_cselect_b32 s85, 155648, s85
    s_cselect_b32 s86, 98304, s86
    v_add_u32 v6, s85, v2
    v_add_u32 v7, s86, v2
    s_waitcnt vmcnt(21)
    v_mfma_f32_32x32x16_bf16 v[64:79], v[40:43], v[152:155], v[64:79]
    v_mfma_f32_32x32x16_bf16 v[80:95], v[40:43], v[156:159], v[80:95]
    v_mfma_f32_32x32x16_bf16 v[96:111], v[44:47], v[152:155], v[96:111]
    v_mfma_f32_32x32x16_bf16 v[112:127], v[44:47], v[156:159], v[112:127]
    s_waitcnt vmcnt(19)
    v_mfma_f32_32x32x16_bf16 v[64:79], v[48:51], v[160:163], v[64:79]
    v_mfma_f32_32x32x16_bf16 v[80:95], v[48:51], v[164:167], v[80:95]
    v_mfma_f32_32x32x16_bf16 v[96:111], v[52:55], v[160:163], v[96:111]
    v_mfma_f32_32x32x16_bf16 v[112:127], v[52:55], v[164:167], v[112:127]
    s_waitcnt vmcnt(17)
    v_mfma_f32_32x32x16_bf16 v[64:79], v[56:59], v[168:171], v[64:79]
    v_mfma_f32_32x32x16_bf16 v[80:95], v[56:59], v[172:175], v[80:95]
    v_mfma_f32_32x32x16_bf16 v[96:111], v[60:63], v[168:171], v[96:111]
    v_mfma_f32_32x32x16_bf16 v[112:127], v[60:63], v[172:175], v[112:127]
    s_waitcnt vmcnt(15)
    v_mfma_f32_32x32x16_bf16 v[64:79], v[16:19], v[176:179], v[64:79]
    v_mfma_f32_32x32x16_bf16 v[80:95], v[16:19], v[180:183], v[80:95]
    v_mfma_f32_32x32x16_bf16 v[96:111], v[20:23], v[176:179], v[96:111]
    v_mfma_f32_32x32x16_bf16 v[112:127], v[20:23], v[180:183], v[112:127]
    s_waitcnt vmcnt(13)
    v_mfma_f32_32x32x16_bf16 v[64:79], v[24:27], v[184:187], v[64:79]
    v_mfma_f32_32x32x16_bf16 v[80:95], v[24:27], v[188:191], v[80:95]
    v_mfma_f32_32x32x16_bf16 v[96:111], v[28:31], v[184:187], v[96:111]
    v_mfma_f32_32x32x16_bf16 v[112:127], v[28:31], v[188:191], v[112:127]
L_p2j_42:
    s_nop 8
    ds_write_b128 v6, v[64:67] offset:0
    ds_write_b128 v6, v[68:71] offset:1024
    ds_write_b128 v6, v[72:75] offset:2048
    ds_write_b128 v6, v[76:79] offset:3072
    ds_write_b128 v6, v[80:83] offset:4096
    ds_write_b128 v6, v[84:87] offset:5120
    ds_write_b128 v6, v[88:91] offset:6144
    ds_write_b128 v6, v[92:95] offset:7168
    ds_write_b128 v7, v[96:99] offset:0
    ds_write_b128 v7, v[100:103] offset:1024
    ds_write_b128 v7, v[104:107] offset:2048
    ds_write_b128 v7, v[108:111] offset:3072
    ds_write_b128 v7, v[112:115] offset:4096
    ds_write_b128 v7, v[116:119] offset:5120
    ds_write_b128 v7, v[120:123] offset:6144
    ds_write_b128 v7, v[124:127] offset:7168
    s_lshl_b32 s87, s77, 11
    v_add_u32 v41, s87, v2
    s_cmp_eq_u32 s78, 0
    s_mov_b32 s88, 8192
    s_cselect_b32 s88, 0, s88
    v_add_u32 v42, s88, v41
    s_mov_b32 s88, 40960
    s_cselect_b32 s88, 32768, s88
    v_add_u32 v43, s88, v41
    s_mov_b32 s88, 139264
    s_cselect_b32 s88, 131072, s88
    v_add_u32 v44, s88, v41
    s_mov_b32 s88, 114688
    s_cselect_b32 s88, 106496, s88
    v_add_u32 v45, s88, v41
    s_mov_b32 s88, 73728
    s_cselect_b32 s88, 65536, s88
    v_add_u32 v46, s88, v41
    s_mov_b32 s88, 90112
    s_cselect_b32 s88, 81920, s88
    v_add_u32 v47, s88, v41
    s_mov_b32 s88, 57344
    s_cselect_b32 s88, 24576, s88
    v_add_u32 v48, s88, v41
    s_mov_b32 s88, 98304
    s_cselect_b32 s88, 155648, s88
    v_add_u32 v49, s88, v41
    s_waitcnt vmcnt(0)
    v_lshlrev_b32 v40, 16, v5
    v_lshlrev_b32 v16, 16, v192
    v_lshlrev_b32 v17, 16, v193
    v_lshlrev_b32 v18, 16, v194
    v_lshlrev_b32 v19, 16, v195
    v_lshlrev_b32 v20, 16, v196
    v_lshlrev_b32 v21, 16, v197
    v_lshlrev_b32 v22, 16, v198
    v_lshlrev_b32 v23, 16, v199
    v_add_f32 v128, v16, v200
    v_add_f32 v129, v17, v202
    v_add_f32 v130, v18, v204
    v_add_f32 v131, v19, v206
    v_add_f32 v132, v20, v208
    v_add_f32 v133, v21, v210
    v_add_f32 v134, v22, v212
    v_add_f32 v135, v23, v214
    v_mul_f32 v128, v128, v201
    v_mul_f32 v129, v129, v203
    v_mul_f32 v130, v130, v205
    v_mul_f32 v131, v131, v207
    v_mul_f32 v132, v132, v209
    v_mul_f32 v133, v133, v211
    v_mul_f32 v134, v134, v213
    v_mul_f32 v135, v135, v215
    s_waitcnt lgkmcnt(0)
    s_barrier
    ds_read_b128 v[64:67], v42 offset:0
    ds_read_b128 v[68:71], v42 offset:1024
    ds_read_b128 v[72:75], v43 offset:0
    ds_read_b128 v[76:79], v43 offset:1024
    ds_read_b128 v[80:83], v44 offset:0
    ds_read_b128 v[84:87], v44 offset:1024
    ds_read_b128 v[88:91], v45 offset:0
    ds_read_b128 v[92:95], v45 offset:1024
    s_waitcnt lgkmcnt(4)
    ds_read_b128 v[96:99], v46 offset:0
    ds_read_b128 v[100:103], v46 offset:1024
    ds_read_b128 v[104:107], v47 offset:0
    ds_read_b128 v[108:111], v47 offset:1024
    ds_read_b128 v[112:115], v48 offset:0
    ds_read_b128 v[116:119], v48 offset:1024
    ds_read_b128 v[120:123], v49 offset:0
    ds_read_b128 v[124:127], v49 offset:1024
    s_waitcnt lgkmcnt(8)
    v_add_f32 v64, v64, v72
    v_add_f32 v80, v80, v88
    v_add_f32 v65, v65, v73
    v_add_f32 v81, v81, v89
    v_add_f32 v66, v66, v74
    v_add_f32 v82, v82, v90
    v_add_f32 v67, v67, v75
    v_add_f32 v83, v83, v91
    v_add_f32 v68, v68, v76
    v_add_f32 v84, v84, v92
    v_add_f32 v69, v69, v77
    v_add_f32 v85, v85, v93
    v_add_f32 v70, v70, v78
    v_add_f32 v86, v86, v94
    v_add_f32 v71, v71, v79
    v_add_f32 v87, v87, v95
    v_add_f32 v64, v64, v80
    v_add_f32 v65, v65, v81
    v_add_f32 v66, v66, v82
    v_add_f32 v67, v67, v83
    v_add_f32 v68, v68, v84
    v_add_f32 v69, v69, v85
    v_add_f32 v70, v70, v86
    v_add_f32 v71, v71, v87
    v_mul_f32 v56, 0xbfb8aa3b, v64
    v_mul_f32 v57, 0xbfb8aa3b, v65
    v_mul_f32 v58, 0xbfb8aa3b, v66
    v_mul_f32 v59, 0xbfb8aa3b, v67
    v_mul_f32 v60, 0xbfb8aa3b, v68
    v_mul_f32 v61, 0xbfb8aa3b, v69
    v_mul_f32 v62, 0xbfb8aa3b, v70
    v_mul_f32 v63, 0xbfb8aa3b, v71
    v_exp_f32 v56, v56
    v_exp_f32 v57, v57
    v_exp_f32 v58, v58
    v_exp_f32 v59, v59
    v_exp_f32 v60, v60
    v_exp_f32 v61, v61
    v_exp_f32 v62, v62
    v_exp_f32 v63, v63
    v_add_f32 v56, 1.0, v56
    v_add_f32 v57, 1.0, v57
    v_add_f32 v58, 1.0, v58
    v_add_f32 v59, 1.0, v59
    v_add_f32 v60, 1.0, v60
    v_add_f32 v61, 1.0, v61
    v_add_f32 v62, 1.0, v62
    v_add_f32 v63, 1.0, v63
    v_rcp_f32 v56, v56
    v_rcp_f32 v57, v57
    v_rcp_f32 v58, v58
    v_rcp_f32 v59, v59
    v_rcp_f32 v60, v60
    v_rcp_f32 v61, v61
    v_rcp_f32 v62, v62
    v_rcp_f32 v63, v63
    v_mul_f32 v56, v64, v56
    v_mul_f32 v57, v65, v57
    v_mul_f32 v58, v66, v58
    v_mul_f32 v59, v67, v59
    v_mul_f32 v60, v68, v60
    v_mul_f32 v61, v69, v61
    v_mul_f32 v62, v70, v62
    v_mul_f32 v63, v71, v63
    s_waitcnt lgkmcnt(0)
    v_add_f32 v96, v96, v104
    v_add_f32 v112, v112, v120
    v_add_f32 v97, v97, v105
    v_add_f32 v113, v113, v121
    v_add_f32 v98, v98, v106
    v_add_f32 v114, v114, v122
    v_add_f32 v99, v99, v107
    v_add_f32 v115, v115, v123
    v_add_f32 v100, v100, v108
    v_add_f32 v116, v116, v124
    v_add_f32 v101, v101, v109
    v_add_f32 v117, v117, v125
    v_add_f32 v102, v102, v110
    v_add_f32 v118, v118, v126
    v_add_f32 v103, v103, v111
    v_add_f32 v119, v119, v127
    v_add_f32 v96, v96, v112
    v_add_f32 v97, v97, v113
    v_add_f32 v98, v98, v114
    v_add_f32 v99, v99, v115
    v_add_f32 v100, v100, v116
    v_add_f32 v101, v101, v117
    v_add_f32 v102, v102, v118
    v_add_f32 v103, v103, v119
    v_fma_f32 v96, v128, v40, v96
    v_fma_f32 v97, v129, v40, v97
    v_fma_f32 v98, v130, v40, v98
    v_fma_f32 v99, v131, v40, v99
    v_fma_f32 v100, v132, v40, v100
    v_fma_f32 v101, v133, v40, v101
    v_fma_f32 v102, v134, v40, v102
    v_fma_f32 v103, v135, v40, v103
    v_fma_f32 v56, v96, v56, v16
    v_fma_f32 v57, v97, v57, v17
    v_fma_f32 v58, v98, v58, v18
    v_fma_f32 v59, v99, v59, v19
    v_fma_f32 v60, v100, v60, v20
    v_fma_f32 v61, v101, v61, v21
    v_fma_f32 v62, v102, v62, v22
    v_fma_f32 v63, v103, v63, v23
    s_add_u32 s85, s4, 0
    buffer_store_dword v56, v13, s[52:55], s85 offen
    s_add_u32 s85, s4, 1792
    buffer_store_dword v57, v13, s[52:55], s85 offen
    s_add_u32 s85, s4, 3584
    buffer_store_dword v58, v13, s[52:55], s85 offen
    s_add_u32 s85, s4, 5376
    buffer_store_dword v59, v13, s[52:55], s85 offen
    s_add_u32 s85, s4, 7168
    buffer_store_dword v60, v13, s[52:55], s85 offen
    s_add_u32 s85, s4, 8960
    buffer_store_dword v61, v13, s[52:55], s85 offen
    s_add_u32 s85, s4, 10752
    buffer_store_dword v62, v13, s[52:55], s85 offen
    s_add_u32 s85, s4, 12544
    buffer_store_dword v63, v13, s[52:55], s85 offen
    s_branch L_end
L_helper:
    v_lshrrev_b32 v4, 3, v0
    v_and_b32 v5, 7, v0
    v_lshrrev_b32 v9, 4, v0
    v_lshlrev_b32 v7, 4, v5
    v_mul_u32_u24 v6, 896, v4
    v_add_u32 v6, v6, v7
    v_mul_u32_u24 v8, 3584, v4
    v_add_u32 v8, v8, v7
    s_waitcnt lgkmcnt(0)
    s_load_dwordx2 s[82:83], s[46:47], 0
    s_mov_b32 s64, s46
    s_mov_b32 s65, s47
    s_mov_b32 s66, 15204352
    s_mov_b32 s67, 0x00020000
    s_cmp_ge_u32 s76, 4
    s_cbranch_scc1 L_hhi_43
    s_mov_b32 s48, s16
    s_mov_b32 s49, s17
    s_mov_b32 s50, 1835008
    s_mov_b32 s51, 0x00020000
    s_lshl_b32 s85, s2, 6
    s_lshl_b32 s86, s76, 4
    s_add_u32 s91, s85, s86
    s_mul_i32 s87, s91, 896
    s_add_u32 s88, s87, 7168
    buffer_load_dwordx4 v[16:19], v6, s[48:51], s87 offen offset:0
    buffer_load_dwordx4 v[20:23], v6, s[48:51], s87 offen offset:128
    buffer_load_dwordx4 v[24:27], v6, s[48:51], s87 offen offset:256
    buffer_load_dwordx4 v[28:31], v6, s[48:51], s87 offen offset:384
    buffer_load_dwordx4 v[32:35], v6, s[48:51], s87 offen offset:512
    buffer_load_dwordx4 v[36:39], v6, s[48:51], s87 offen offset:640
    buffer_load_dwordx4 v[40:43], v6, s[48:51], s87 offen offset:768
    buffer_load_dwordx4 v[44:47], v6, s[48:51], s88 offen offset:0
    buffer_load_dwordx4 v[48:51], v6, s[48:51], s88 offen offset:128
    buffer_load_dwordx4 v[52:55], v6, s[48:51], s88 offen offset:256
    buffer_load_dwordx4 v[56:59], v6, s[48:51], s88 offen offset:384
    buffer_load_dwordx4 v[60:63], v6, s[48:51], s88 offen offset:512
    buffer_load_dwordx4 v[64:67], v6, s[48:51], s88 offen offset:640
    buffer_load_dwordx4 v[68:71], v6, s[48:51], s88 offen offset:768
    s_cmp_ge_u32 s2, 28
    s_cbranch_scc1 L_hnB_44
    s_lshr_b32 s85, s76, 1
    s_cmp_eq_u32 s85, 0
    s_cselect_b32 s52, s22, s24
    s_cselect_b32 s53, s23, s25
    s_mov_b32 s54, 401408
    s_mov_b32 s55, 0x00020000
    s_and_b32 s89, s76, 1
    s_lshl_b32 s89, s89, 3
    s_lshl_b32 s90, s2, 4
    s_add_u32 s92, s89, s90
    s_mul_i32 s89, s92, 896
    buffer_load_dwordx4 v[72:75], v6, s[52:55], s89 offen offset:0
    buffer_load_dwordx4 v[76:79], v6, s[52:55], s89 offen offset:128
    buffer_load_dwordx4 v[80:83], v6, s[52:55], s89 offen offset:256
    buffer_load_dwordx4 v[84:87], v6, s[52:55], s89 offen offset:384
    buffer_load_dwordx4 v[88:91], v6, s[52:55], s89 offen offset:512
    buffer_load_dwordx4 v[92:95], v6, s[52:55], s89 offen offset:640
    buffer_load_dwordx4 v[96:99], v6, s[52:55], s89 offen offset:768
    s_waitcnt vmcnt(7)
    s_branch L_hjB_45
L_hnB_44:
    s_waitcnt vmcnt(0)
L_hjB_45:
    s_waitcnt lgkmcnt(0)
    s_add_u32 s82, s82, 1
    s_and_b32 s5, s83, 0xffff
    s_mov_b32 s4, 0x3f803f80
    v_mov_b32 v192, 0
    v_mov_b32 v193, 0
    v_mov_b32 v194, 0
    v_mov_b32 v195, 0
    v_mov_b32 v200, 0
    v_mov_b32 v201, 0
    v_mov_b32 v202, 0
    v_mov_b32 v203, 0
    v_dot2_f32_bf16 v192, v16, s4, v192
    v_dot2_f32_bf16 v194, v16, v16, v194
    v_dot2_f32_bf16 v200, v44, s4, v200
    v_dot2_f32_bf16 v202, v44, v44, v202
    v_dot2_f32_bf16 v193, v17, s4, v193
    v_dot2_f32_bf16 v195, v17, v17, v195
    v_dot2_f32_bf16 v201, v45, s4, v201
    v_dot2_f32_bf16 v203, v45, v45, v203
    v_dot2_f32_bf16 v192, v18, s4, v192
    v_dot2_f32_bf16 v194, v18, v18, v194
    v_dot2_f32_bf16 v200, v46, s4, v200
    v_dot2_f32_bf16 v202, v46, v46, v202
    v_dot2_f32_bf16 v193, v19, s4, v193
    v_dot2_f32_bf16 v195, v19, v19, v195
    v_dot2_f32_bf16 v201, v47, s4, v201
    v_dot2_f32_bf16 v203, v47, v47, v203
    v_dot2_f32_bf16 v192, v20, s4, v192
    v_dot2_f32_bf16 v194, v20, v20, v194
    v_dot2_f32_bf16 v200, v48, s4, v200
    v_dot2_f32_bf16 v202, v48, v48, v202
    v_dot2_f32_bf16 v193, v21, s4, v193
    v_dot2_f32_bf16 v195, v21, v21, v195
    v_dot2_f32_bf16 v201, v49, s4, v201
    v_dot2_f32_bf16 v203, v49, v49, v203
    v_dot2_f32_bf16 v192, v22, s4, v192
    v_dot2_f32_bf16 v194, v22, v22, v194
    v_dot2_f32_bf16 v200, v50, s4, v200
    v_dot2_f32_bf16 v202, v50, v50, v202
    v_dot2_f32_bf16 v193, v23, s4, v193
    v_dot2_f32_bf16 v195, v23, v23, v195
    v_dot2_f32_bf16 v201, v51, s4, v201
    v_dot2_f32_bf16 v203, v51, v51, v203
    v_dot2_f32_bf16 v192, v24, s4, v192
    v_dot2_f32_bf16 v194, v24, v24, v194
    v_dot2_f32_bf16 v200, v52, s4, v200
    v_dot2_f32_bf16 v202, v52, v52, v202
    v_dot2_f32_bf16 v193, v25, s4, v193
    v_dot2_f32_bf16 v195, v25, v25, v195
    v_dot2_f32_bf16 v201, v53, s4, v201
    v_dot2_f32_bf16 v203, v53, v53, v203
    v_dot2_f32_bf16 v192, v26, s4, v192
    v_dot2_f32_bf16 v194, v26, v26, v194
    v_dot2_f32_bf16 v200, v54, s4, v200
    v_dot2_f32_bf16 v202, v54, v54, v202
    v_dot2_f32_bf16 v193, v27, s4, v193
    v_dot2_f32_bf16 v195, v27, v27, v195
    v_dot2_f32_bf16 v201, v55, s4, v201
    v_dot2_f32_bf16 v203, v55, v55, v203
    v_dot2_f32_bf16 v192, v28, s4, v192
    v_dot2_f32_bf16 v194, v28, v28, v194
    v_dot2_f32_bf16 v200, v56, s4, v200
    v_dot2_f32_bf16 v202, v56, v56, v202
    v_dot2_f32_bf16 v193, v29, s4, v193
    v_dot2_f32_bf16 v195, v29, v29, v195
    v_dot2_f32_bf16 v201, v57, s4, v201
    v_dot2_f32_bf16 v203, v57, v57, v203
    v_dot2_f32_bf16 v192, v30, s4, v192
    v_dot2_f32_bf16 v194, v30, v30, v194
    v_dot2_f32_bf16 v200, v58, s4, v200
    v_dot2_f32_bf16 v202, v58, v58, v202
    v_dot2_f32_bf16 v193, v31, s4, v193
    v_dot2_f32_bf16 v195, v31, v31, v195
    v_dot2_f32_bf16 v201, v59, s4, v201
    v_dot2_f32_bf16 v203, v59, v59, v203
    v_dot2_f32_bf16 v192, v32, s4, v192
    v_dot2_f32_bf16 v194, v32, v32, v194
    v_dot2_f32_bf16 v200, v60, s4, v200
    v_dot2_f32_bf16 v202, v60, v60, v202
    v_dot2_f32_bf16 v193, v33, s4, v193
    v_dot2_f32_bf16 v195, v33, v33, v195
    v_dot2_f32_bf16 v201, v61, s4, v201
    v_dot2_f32_bf16 v203, v61, v61, v203
    v_dot2_f32_bf16 v192, v34, s4, v192
    v_dot2_f32_bf16 v194, v34, v34, v194
    v_dot2_f32_bf16 v200, v62, s4, v200
    v_dot2_f32_bf16 v202, v62, v62, v202
    v_dot2_f32_bf16 v193, v35, s4, v193
    v_dot2_f32_bf16 v195, v35, v35, v195
    v_dot2_f32_bf16 v201, v63, s4, v201
    v_dot2_f32_bf16 v203, v63, v63, v203
    v_dot2_f32_bf16 v192, v36, s4, v192
    v_dot2_f32_bf16 v194, v36, v36, v194
    v_dot2_f32_bf16 v200, v64, s4, v200
    v_dot2_f32_bf16 v202, v64, v64, v202
    v_dot2_f32_bf16 v193, v37, s4, v193
    v_dot2_f32_bf16 v195, v37, v37, v195
    v_dot2_f32_bf16 v201, v65, s4, v201
    v_dot2_f32_bf16 v203, v65, v65, v203
    v_dot2_f32_bf16 v192, v38, s4, v192
    v_dot2_f32_bf16 v194, v38, v38, v194
    v_dot2_f32_bf16 v200, v66, s4, v200
    v_dot2_f32_bf16 v202, v66, v66, v202
    v_dot2_f32_bf16 v193, v39, s4, v193
    v_dot2_f32_bf16 v195, v39, v39, v195
    v_dot2_f32_bf16 v201, v67, s4, v201
    v_dot2_f32_bf16 v203, v67, v67, v203
    v_dot2_f32_bf16 v192, v40, s4, v192
    v_dot2_f32_bf16 v194, v40, v40, v194
    v_dot2_f32_bf16 v200, v68, s4, v200
    v_dot2_f32_bf16 v202, v68, v68, v202
    v_dot2_f32_bf16 v193, v41, s4, v193
    v_dot2_f32_bf16 v195, v41, v41, v195
    v_dot2_f32_bf16 v201, v69, s4, v201
    v_dot2_f32_bf16 v203, v69, v69, v203
    v_dot2_f32_bf16 v192, v42, s4, v192
    v_dot2_f32_bf16 v194, v42, v42, v194
    v_dot2_f32_bf16 v200, v70, s4, v200
    v_dot2_f32_bf16 v202, v70, v70, v202
    v_dot2_f32_bf16 v193, v43, s4, v193
    v_dot2_f32_bf16 v195, v43, v43, v195
    v_dot2_f32_bf16 v201, v71, s4, v201
    v_dot2_f32_bf16 v203, v71, v71, v203
    v_add_f32 v192, v192, v193
    v_add_f32 v194, v194, v195
    v_add_f32 v200, v200, v201
    v_add_f32 v202, v202, v203
    v_add_f32_dpp v192, v192, v192 quad_perm:[1,0,3,2] row_mask:0xf bank_mask:0xf
    s_nop 1
    v_add_f32_dpp v192, v192, v192 quad_perm:[2,3,0,1] row_mask:0xf bank_mask:0xf
    s_nop 1
    v_add_f32_dpp v192, v192, v192 row_half_mirror row_mask:0xf bank_mask:0xf
    v_add_f32_dpp v194, v194, v194 quad_perm:[1,0,3,2] row_mask:0xf bank_mask:0xf
    s_nop 1
    v_add_f32_dpp v194, v194, v194 quad_perm:[2,3,0,1] row_mask:0xf bank_mask:0xf
    s_nop 1
    v_add_f32_dpp v194, v194, v194 row_half_mirror row_mask:0xf bank_mask:0xf
    v_add_f32_dpp v200, v200, v200 quad_perm:[1,0,3,2] row_mask:0xf bank_mask:0xf
    s_nop 1
    v_add_f32_dpp v200, v200, v200 quad_perm:[2,3,0,1] row_mask:0xf bank_mask:0xf
    s_nop 1
    v_add_f32_dpp v200, v200, v200 row_half_mirror row_mask:0xf bank_mask:0xf
    v_add_f32_dpp v202, v202, v202 quad_perm:[1,0,3,2] row_mask:0xf bank_mask:0xf
    s_nop 1
    v_add_f32_dpp v202, v202, v202 quad_perm:[2,3,0,1] row_mask:0xf bank_mask:0xf
    s_nop 1
    v_add_f32_dpp v202, v202, v202 row_half_mirror row_mask:0xf bank_mask:0xf
    v_mul_f32 v192, 0x3b124925, v192
    v_mul_f32 v194, 0x3b124925, v194
    v_fma_f32 v194, -v192, v192, v194
    v_max_f32 v194, 0, v194
    v_cvt_pk_bf16_f32 v192, v192, v192
    v_and_b32 v192, 0xffff0000, v192
    v_cvt_pk_bf16_f32 v194, v194, v194
    v_and_b32 v194, 0xffff0000, v194
    v_add_f32 v194, 0x3727c5ac, v194
    v_cvt_pk_bf16_f32 v194, v194, v194
    v_and_b32 v194, 0xffff0000, v194
    v_sqrt_f32 v194, v194
    s_nop 0
    v_cvt_pk_bf16_f32 v194, v194, v194
    v_and_b32 v194, 0xffff0000, v194
    v_rcp_f32 v195, v194
    s_nop 0
    v_fma_f32 v196, -v194, v195, 2.0
    v_mul_f32 v195, v195, v196
    v_sub_f32 v208, 0, v192
    v_mul_f32 v209, 0xbfb8aa3b, v195
    v_or_b32 v210, s5, v194
    v_mov_b32 v211, s82
    v_mov_b32 v212, v208
    v_mov_b32 v213, v195
    v_mul_f32 v200, 0x3b124925, v200
    v_mul_f32 v202, 0x3b124925, v202
    v_fma_f32 v202, -v200, v200, v202
    v_max_f32 v202, 0, v202
    v_cvt_pk_bf16_f32 v200, v200, v200
    v_and_b32 v200, 0xffff0000, v200
    v_cvt_pk_bf16_f32 v202, v202, v202
    v_and_b32 v202, 0xffff0000, v202
    v_add_f32 v202, 0x3727c5ac, v202
    v_cvt_pk_bf16_f32 v202, v202, v202
    v_and_b32 v202, 0xffff0000, v202
    v_sqrt_f32 v202, v202
    s_nop 0
    v_cvt_pk_bf16_f32 v202, v202, v202
    v_and_b32 v202, 0xffff0000, v202
    v_rcp_f32 v203, v202
    s_nop 0
    v_fma_f32 v204, -v202, v203, 2.0
    v_mul_f32 v203, v203, v204
    v_sub_f32 v216, 0, v200
    v_mul_f32 v217, 0xbfb8aa3b, v203
    v_or_b32 v218, s5, v202
    v_mov_b32 v219, s82
    v_mov_b32 v220, v216
    v_mov_b32 v221, v203
    v_add_u32 v12, s91, v4
    v_lshlrev_b32 v13, 4, v12
    v_lshlrev_b32 v14, 3, v12
    v_cmp_eq_u32 vcc, 0, v5
    s_nop 0
    s_and_saveexec_b64 s[96:97], vcc
    s_mov_b32 s85, 196608
    s_mov_b32 s86, 229376
    buffer_store_dwordx4 v[208:211], v13, s[64:67], s85 offen offset:0 sc1
    buffer_store_dwordx2 v[212:213], v14, s[64:67], s86 offen offset:0 sc1
    buffer_store_dwordx4 v[216:219], v13, s[64:67], s85 offen offset:128 sc1
    buffer_store_dwordx2 v[220:221], v14, s[64:67], s86 offen offset:64 sc1
    s_mov_b64 exec, s[96:97]
    s_cmp_ge_u32 s2, 28
    s_cbranch_scc1 L_honly_46
    s_waitcnt vmcnt(4)
    v_mov_b32 v196, 0
    v_mov_b32 v197, 0
    v_dot2_f32_bf16 v196, v72, s4, v196
    v_dot2_f32_bf16 v197, v73, s4, v197
    v_dot2_f32_bf16 v196, v74, s4, v196
    v_dot2_f32_bf16 v197, v75, s4, v197
    v_dot2_f32_bf16 v196, v76, s4, v196
    v_dot2_f32_bf16 v197, v77, s4, v197
    v_dot2_f32_bf16 v196, v78, s4, v196
    v_dot2_f32_bf16 v197, v79, s4, v197
    v_dot2_f32_bf16 v196, v80, s4, v196
    v_dot2_f32_bf16 v197, v81, s4, v197
    v_dot2_f32_bf16 v196, v82, s4, v196
    v_dot2_f32_bf16 v197, v83, s4, v197
    v_dot2_f32_bf16 v196, v84, s4, v196
    v_dot2_f32_bf16 v197, v85, s4, v197
    v_dot2_f32_bf16 v196, v86, s4, v196
    v_dot2_f32_bf16 v197, v87, s4, v197
    v_dot2_f32_bf16 v196, v88, s4, v196
    v_dot2_f32_bf16 v197, v89, s4, v197
    v_dot2_f32_bf16 v196, v90, s4, v196
    v_dot2_f32_bf16 v197, v91, s4, v197
    v_dot2_f32_bf16 v196, v92, s4, v196
    v_dot2_f32_bf16 v197, v93, s4, v197
    v_dot2_f32_bf16 v196, v94, s4, v196
    v_dot2_f32_bf16 v197, v95, s4, v197
    v_dot2_f32_bf16 v196, v96, s4, v196
    v_dot2_f32_bf16 v197, v97, s4, v197
    v_dot2_f32_bf16 v196, v98, s4, v196
    v_dot2_f32_bf16 v197, v99, s4, v197
    s_nop 2
    v_add_f32 v196, v196, v197
    s_nop 1
    v_add_f32_dpp v196, v196, v196 quad_perm:[1,0,3,2] row_mask:0xf bank_mask:0xf
    s_nop 1
    v_add_f32_dpp v196, v196, v196 quad_perm:[2,3,0,1] row_mask:0xf bank_mask:0xf
    s_nop 1
    v_add_f32_dpp v196, v196, v196 row_half_mirror row_mask:0xf bank_mask:0xf
    s_lshl_b32 s85, s2, 9
    s_lshr_b32 s86, s76, 1
    s_lshl_b32 s86, s86, 8
    s_add_u32 s85, s85, s86
    s_and_b32 s86, s76, 1
    s_lshl_b32 s86, s86, 7
    s_add_u32 s85, s85, s86
    s_add_u32 s85, s85, 278528
    v_mov_b32 v197, 0
    v_mov_b32 v198, s5
    v_mov_b32 v199, s82
    v_lshlrev_b32 v12, 4, v4
    v_cmp_eq_u32 vcc, 0, v5
    s_nop 0
    s_and_saveexec_b64 s[96:97], vcc
    buffer_store_dwordx4 v[196:199], v12, s[64:67], s85 offen sc1
    s_mov_b64 exec, s[96:97]
L_honly_46:
    s_waitcnt vmcnt(0)
    s_lshl_b32 s85, s2, 7
    s_lshl_b32 s86, s76, 3
    s_add_u32 s85, s85, s86
    s_add_u32 s85, s85, 12288
    v_mov_b32 v12, 0
    v_mov_b32 v10, s82
    v_mov_b32 v11, s83
    s_mov_b64 s[96:97], exec
    s_mov_b64 exec, 1
    buffer_store_dwordx2 v[10:11], v12, s[64:67], s85 offen sc1
    s_mov_b64 exec, s[96:97]
    s_branch L_hfin
L_hhi_43:
    s_cmp_ge_u32 s2, 28
    s_cbranch_scc1 L_hupd
    s_sub_u32 s7, s76, 4
    s_mov_b32 s56, s36
    s_mov_b32 s57, s37
    s_mov_b32 s58, 1605632
    s_mov_b32 s59, 0x00020000
    s_mov_b32 s60, s38
    s_mov_b32 s61, s39
    s_mov_b32 s62, 1605632
    s_mov_b32 s63, 0x00020000
    s_mul_i32 s88, s7, 401408
    s_lshl_b32 s89, s2, 7
    s_add_u32 s88, s88, s89
    s_add_u32 s89, s88, 0
    buffer_load_dwordx4 v[16:19], v8, s[56:59], s89 offen
    buffer_load_dwordx4 v[72:75], v8, s[60:63], s89 offen
    s_add_u32 s89, s88, 28672
    buffer_load_dwordx4 v[20:23], v8, s[56:59], s89 offen
    buffer_load_dwordx4 v[76:79], v8, s[60:63], s89 offen
    s_add_u32 s89, s88, 57344
    buffer_load_dwordx4 v[24:27], v8, s[56:59], s89 offen
    buffer_load_dwordx4 v[80:83], v8, s[60:63], s89 offen
    s_add_u32 s89, s88, 86016
    buffer_load_dwordx4 v[28:31], v8, s[56:59], s89 offen
    buffer_load_dwordx4 v[84:87], v8, s[60:63], s89 offen
    s_add_u32 s89, s88, 114688
    buffer_load_dwordx4 v[32:35], v8, s[56:59], s89 offen
    buffer_load_dwordx4 v[88:91], v8, s[60:63], s89 offen
    s_add_u32 s89, s88, 143360
    buffer_load_dwordx4 v[36:39], v8, s[56:59], s89 offen
    buffer_load_dwordx4 v[92:95], v8, s[60:63], s89 offen
    s_add_u32 s89, s88, 172032
    buffer_load_dwordx4 v[40:43], v8, s[56:59], s89 offen
    buffer_load_dwordx4 v[96:99], v8, s[60:63], s89 offen
    s_add_u32 s89, s88, 200704
    buffer_load_dwordx4 v[44:47], v8, s[56:59], s89 offen
    buffer_load_dwordx4 v[100:103], v8, s[60:63], s89 offen
    s_add_u32 s89, s88, 229376
    buffer_load_dwordx4 v[48:51], v8, s[56:59], s89 offen
    buffer_load_dwordx4 v[104:107], v8, s[60:63], s89 offen
    s_add_u32 s89, s88, 258048
    buffer_load_dwordx4 v[52:55], v8, s[56:59], s89 offen
    buffer_load_dwordx4 v[108:111], v8, s[60:63], s89 offen
    s_add_u32 s89, s88, 286720
    buffer_load_dwordx4 v[56:59], v8, s[56:59], s89 offen
    buffer_load_dwordx4 v[112:115], v8, s[60:63], s89 offen
    s_add_u32 s89, s88, 315392
    buffer_load_dwordx4 v[60:63], v8, s[56:59], s89 offen
    buffer_load_dwordx4 v[116:119], v8, s[60:63], s89 offen
    s_add_u32 s89, s88, 344064
    buffer_load_dwordx4 v[64:67], v8, s[56:59], s89 offen
    buffer_load_dwordx4 v[120:123], v8, s[60:63], s89 offen
    s_add_u32 s89, s88, 372736
    buffer_load_dwordx4 v[68:71], v8, s[56:59], s89 offen
    buffer_load_dwordx4 v[124:127], v8, s[60:63], s89 offen
    s_mov_b32 s5, 0x00003f80
    s_mov_b32 s6, 0x3f800000
    v_mov_b32 v192, 0
    v_mov_b32 v193, 0
    v_mov_b32 v194, 0
    v_mov_b32 v195, 0
    v_mov_b32 v196, 0
    v_mov_b32 v197, 0
    v_mov_b32 v198, 0
    v_mov_b32 v199, 0
    v_mov_b32 v200, 0
    v_mov_b32 v201, 0
    v_mov_b32 v202, 0
    v_mov_b32 v203, 0
    v_mov_b32 v204, 0
    v_mov_b32 v205, 0
    v_mov_b32 v206, 0
    v_mov_b32 v207, 0
    s_waitcnt vmcnt(26)
    v_dot2_f32_bf16 v192, v16, s5, v192
    v_dot2_f32_bf16 v193, v16, s6, v193
    v_dot2_f32_bf16 v194, v17, s5, v194
    v_dot2_f32_bf16 v195, v17, s6, v195
    v_dot2_f32_bf16 v196, v18, s5, v196
    v_dot2_f32_bf16 v197, v18, s6, v197
    v_dot2_f32_bf16 v198, v19, s5, v198
    v_dot2_f32_bf16 v199, v19, s6, v199
    v_dot2_f32_bf16 v200, v72, s5, v200
    v_dot2_f32_bf16 v201, v72, s6, v201
    v_dot2_f32_bf16 v202, v73, s5, v202
    v_dot2_f32_bf16 v203, v73, s6, v203
    v_dot2_f32_bf16 v204, v74, s5, v204
    v_dot2_f32_bf16 v205, v74, s6, v205
    v_dot2_f32_bf16 v206, v75, s5, v206
    v_dot2_f32_bf16 v207, v75, s6, v207
    s_waitcnt vmcnt(24)
    v_dot2_f32_bf16 v192, v20, s5, v192
    v_dot2_f32_bf16 v193, v20, s6, v193
    v_dot2_f32_bf16 v194, v21, s5, v194
    v_dot2_f32_bf16 v195, v21, s6, v195
    v_dot2_f32_bf16 v196, v22, s5, v196
    v_dot2_f32_bf16 v197, v22, s6, v197
    v_dot2_f32_bf16 v198, v23, s5, v198
    v_dot2_f32_bf16 v199, v23, s6, v199
    v_dot2_f32_bf16 v200, v76, s5, v200
    v_dot2_f32_bf16 v201, v76, s6, v201
    v_dot2_f32_bf16 v202, v77, s5, v202
    v_dot2_f32_bf16 v203, v77, s6, v203
    v_dot2_f32_bf16 v204, v78, s5, v204
    v_dot2_f32_bf16 v205, v78, s6, v205
    v_dot2_f32_bf16 v206, v79, s5, v206
    v_dot2_f32_bf16 v207, v79, s6, v207
    s_waitcnt vmcnt(22)
    v_dot2_f32_bf16 v192, v24, s5, v192
    v_dot2_f32_bf16 v193, v24, s6, v193
    v_dot2_f32_bf16 v194, v25, s5, v194
    v_dot2_f32_bf16 v195, v25, s6, v195
    v_dot2_f32_bf16 v196, v26, s5, v196
    v_dot2_f32_bf16 v197, v26, s6, v197
    v_dot2_f32_bf16 v198, v27, s5, v198
    v_dot2_f32_bf16 v199, v27, s6, v199
    v_dot2_f32_bf16 v200, v80, s5, v200
    v_dot2_f32_bf16 v201, v80, s6, v201
    v_dot2_f32_bf16 v202, v81, s5, v202
    v_dot2_f32_bf16 v203, v81, s6, v203
    v_dot2_f32_bf16 v204, v82, s5, v204
    v_dot2_f32_bf16 v205, v82, s6, v205
    v_dot2_f32_bf16 v206, v83, s5, v206
    v_dot2_f32_bf16 v207, v83, s6, v207
    s_waitcnt vmcnt(20)
    v_dot2_f32_bf16 v192, v28, s5, v192
    v_dot2_f32_bf16 v193, v28, s6, v193
    v_dot2_f32_bf16 v194, v29, s5, v194
    v_dot2_f32_bf16 v195, v29, s6, v195
    v_dot2_f32_bf16 v196, v30, s5, v196
    v_dot2_f32_bf16 v197, v30, s6, v197
    v_dot2_f32_bf16 v198, v31, s5, v198
    v_dot2_f32_bf16 v199, v31, s6, v199
    v_dot2_f32_bf16 v200, v84, s5, v200
    v_dot2_f32_bf16 v201, v84, s6, v201
    v_dot2_f32_bf16 v202, v85, s5, v202
    v_dot2_f32_bf16 v203, v85, s6, v203
    v_dot2_f32_bf16 v204, v86, s5, v204
    v_dot2_f32_bf16 v205, v86, s6, v205
    v_dot2_f32_bf16 v206, v87, s5, v206
    v_dot2_f32_bf16 v207, v87, s6, v207
    s_waitcnt vmcnt(18)
    v_dot2_f32_bf16 v192, v32, s5, v192
    v_dot2_f32_bf16 v193, v32, s6, v193
    v_dot2_f32_bf16 v194, v33, s5, v194
    v_dot2_f32_bf16 v195, v33, s6, v195
    v_dot2_f32_bf16 v196, v34, s5, v196
    v_dot2_f32_bf16 v197, v34, s6, v197
    v_dot2_f32_bf16 v198, v35, s5, v198
    v_dot2_f32_bf16 v199, v35, s6, v199
    v_dot2_f32_bf16 v200, v88, s5, v200
    v_dot2_f32_bf16 v201, v88, s6, v201
    v_dot2_f32_bf16 v202, v89, s5, v202
    v_dot2_f32_bf16 v203, v89, s6, v203
    v_dot2_f32_bf16 v204, v90, s5, v204
    v_dot2_f32_bf16 v205, v90, s6, v205
    v_dot2_f32_bf16 v206, v91, s5, v206
    v_dot2_f32_bf16 v207, v91, s6, v207
    s_waitcnt vmcnt(16)
    v_dot2_f32_bf16 v192, v36, s5, v192
    v_dot2_f32_bf16 v193, v36, s6, v193
    v_dot2_f32_bf16 v194, v37, s5, v194
    v_dot2_f32_bf16 v195, v37, s6, v195
    v_dot2_f32_bf16 v196, v38, s5, v196
    v_dot2_f32_bf16 v197, v38, s6, v197
    v_dot2_f32_bf16 v198, v39, s5, v198
    v_dot2_f32_bf16 v199, v39, s6, v199
    v_dot2_f32_bf16 v200, v92, s5, v200
    v_dot2_f32_bf16 v201, v92, s6, v201
    v_dot2_f32_bf16 v202, v93, s5, v202
    v_dot2_f32_bf16 v203, v93, s6, v203
    v_dot2_f32_bf16 v204, v94, s5, v204
    v_dot2_f32_bf16 v205, v94, s6, v205
    v_dot2_f32_bf16 v206, v95, s5, v206
    v_dot2_f32_bf16 v207, v95, s6, v207
    s_waitcnt vmcnt(14)
    v_dot2_f32_bf16 v192, v40, s5, v192
    v_dot2_f32_bf16 v193, v40, s6, v193
    v_dot2_f32_bf16 v194, v41, s5, v194
    v_dot2_f32_bf16 v195, v41, s6, v195
    v_dot2_f32_bf16 v196, v42, s5, v196
    v_dot2_f32_bf16 v197, v42, s6, v197
    v_dot2_f32_bf16 v198, v43, s5, v198
    v_dot2_f32_bf16 v199, v43, s6, v199
    v_dot2_f32_bf16 v200, v96, s5, v200
    v_dot2_f32_bf16 v201, v96, s6, v201
    v_dot2_f32_bf16 v202, v97, s5, v202
    v_dot2_f32_bf16 v203, v97, s6, v203
    v_dot2_f32_bf16 v204, v98, s5, v204
    v_dot2_f32_bf16 v205, v98, s6, v205
    v_dot2_f32_bf16 v206, v99, s5, v206
    v_dot2_f32_bf16 v207, v99, s6, v207
    s_waitcnt vmcnt(12)
    v_dot2_f32_bf16 v192, v44, s5, v192
    v_dot2_f32_bf16 v193, v44, s6, v193
    v_dot2_f32_bf16 v194, v45, s5, v194
    v_dot2_f32_bf16 v195, v45, s6, v195
    v_dot2_f32_bf16 v196, v46, s5, v196
    v_dot2_f32_bf16 v197, v46, s6, v197
    v_dot2_f32_bf16 v198, v47, s5, v198
    v_dot2_f32_bf16 v199, v47, s6, v199
    v_dot2_f32_bf16 v200, v100, s5, v200
    v_dot2_f32_bf16 v201, v100, s6, v201
    v_dot2_f32_bf16 v202, v101, s5, v202
    v_dot2_f32_bf16 v203, v101, s6, v203
    v_dot2_f32_bf16 v204, v102, s5, v204
    v_dot2_f32_bf16 v205, v102, s6, v205
    v_dot2_f32_bf16 v206, v103, s5, v206
    v_dot2_f32_bf16 v207, v103, s6, v207
    s_waitcnt vmcnt(10)
    v_dot2_f32_bf16 v192, v48, s5, v192
    v_dot2_f32_bf16 v193, v48, s6, v193
    v_dot2_f32_bf16 v194, v49, s5, v194
    v_dot2_f32_bf16 v195, v49, s6, v195
    v_dot2_f32_bf16 v196, v50, s5, v196
    v_dot2_f32_bf16 v197, v50, s6, v197
    v_dot2_f32_bf16 v198, v51, s5, v198
    v_dot2_f32_bf16 v199, v51, s6, v199
    v_dot2_f32_bf16 v200, v104, s5, v200
    v_dot2_f32_bf16 v201, v104, s6, v201
    v_dot2_f32_bf16 v202, v105, s5, v202
    v_dot2_f32_bf16 v203, v105, s6, v203
    v_dot2_f32_bf16 v204, v106, s5, v204
    v_dot2_f32_bf16 v205, v106, s6, v205
    v_dot2_f32_bf16 v206, v107, s5, v206
    v_dot2_f32_bf16 v207, v107, s6, v207
    s_waitcnt vmcnt(8)
    v_dot2_f32_bf16 v192, v52, s5, v192
    v_dot2_f32_bf16 v193, v52, s6, v193
    v_dot2_f32_bf16 v194, v53, s5, v194
    v_dot2_f32_bf16 v195, v53, s6, v195
    v_dot2_f32_bf16 v196, v54, s5, v196
    v_dot2_f32_bf16 v197, v54, s6, v197
    v_dot2_f32_bf16 v198, v55, s5, v198
    v_dot2_f32_bf16 v199, v55, s6, v199
    v_dot2_f32_bf16 v200, v108, s5, v200
    v_dot2_f32_bf16 v201, v108, s6, v201
    v_dot2_f32_bf16 v202, v109, s5, v202
    v_dot2_f32_bf16 v203, v109, s6, v203
    v_dot2_f32_bf16 v204, v110, s5, v204
    v_dot2_f32_bf16 v205, v110, s6, v205
    v_dot2_f32_bf16 v206, v111, s5, v206
    v_dot2_f32_bf16 v207, v111, s6, v207
    s_waitcnt vmcnt(6)
    v_dot2_f32_bf16 v192, v56, s5, v192
    v_dot2_f32_bf16 v193, v56, s6, v193
    v_dot2_f32_bf16 v194, v57, s5, v194
    v_dot2_f32_bf16 v195, v57, s6, v195
    v_dot2_f32_bf16 v196, v58, s5, v196
    v_dot2_f32_bf16 v197, v58, s6, v197
    v_dot2_f32_bf16 v198, v59, s5, v198
    v_dot2_f32_bf16 v199, v59, s6, v199
    v_dot2_f32_bf16 v200, v112, s5, v200
    v_dot2_f32_bf16 v201, v112, s6, v201
    v_dot2_f32_bf16 v202, v113, s5, v202
    v_dot2_f32_bf16 v203, v113, s6, v203
    v_dot2_f32_bf16 v204, v114, s5, v204
    v_dot2_f32_bf16 v205, v114, s6, v205
    v_dot2_f32_bf16 v206, v115, s5, v206
    v_dot2_f32_bf16 v207, v115, s6, v207
    s_waitcnt vmcnt(4)
    v_dot2_f32_bf16 v192, v60, s5, v192
    v_dot2_f32_bf16 v193, v60, s6, v193
    v_dot2_f32_bf16 v194, v61, s5, v194
    v_dot2_f32_bf16 v195, v61, s6, v195
    v_dot2_f32_bf16 v196, v62, s5, v196
    v_dot2_f32_bf16 v197, v62, s6, v197
    v_dot2_f32_bf16 v198, v63, s5, v198
    v_dot2_f32_bf16 v199, v63, s6, v199
    v_dot2_f32_bf16 v200, v116, s5, v200
    v_dot2_f32_bf16 v201, v116, s6, v201
    v_dot2_f32_bf16 v202, v117, s5, v202
    v_dot2_f32_bf16 v203, v117, s6, v203
    v_dot2_f32_bf16 v204, v118, s5, v204
    v_dot2_f32_bf16 v205, v118, s6, v205
    v_dot2_f32_bf16 v206, v119, s5, v206
    v_dot2_f32_bf16 v207, v119, s6, v207
    s_waitcnt vmcnt(2)
    v_dot2_f32_bf16 v192, v64, s5, v192
    v_dot2_f32_bf16 v193, v64, s6, v193
    v_dot2_f32_bf16 v194, v65, s5, v194
    v_dot2_f32_bf16 v195, v65, s6, v195
    v_dot2_f32_bf16 v196, v66, s5, v196
    v_dot2_f32_bf16 v197, v66, s6, v197
    v_dot2_f32_bf16 v198, v67, s5, v198
    v_dot2_f32_bf16 v199, v67, s6, v199
    v_dot2_f32_bf16 v200, v120, s5, v200
    v_dot2_f32_bf16 v201, v120, s6, v201
    v_dot2_f32_bf16 v202, v121, s5, v202
    v_dot2_f32_bf16 v203, v121, s6, v203
    v_dot2_f32_bf16 v204, v122, s5, v204
    v_dot2_f32_bf16 v205, v122, s6, v205
    v_dot2_f32_bf16 v206, v123, s5, v206
    v_dot2_f32_bf16 v207, v123, s6, v207
    s_waitcnt vmcnt(0)
    v_dot2_f32_bf16 v192, v68, s5, v192
    v_dot2_f32_bf16 v193, v68, s6, v193
    v_dot2_f32_bf16 v194, v69, s5, v194
    v_dot2_f32_bf16 v195, v69, s6, v195
    v_dot2_f32_bf16 v196, v70, s5, v196
    v_dot2_f32_bf16 v197, v70, s6, v197
    v_dot2_f32_bf16 v198, v71, s5, v198
    v_dot2_f32_bf16 v199, v71, s6, v199
    v_dot2_f32_bf16 v200, v124, s5, v200
    v_dot2_f32_bf16 v201, v124, s6, v201
    v_dot2_f32_bf16 v202, v125, s5, v202
    v_dot2_f32_bf16 v203, v125, s6, v203
    v_dot2_f32_bf16 v204, v126, s5, v204
    v_dot2_f32_bf16 v205, v126, s6, v205
    v_dot2_f32_bf16 v206, v127, s5, v206
    v_dot2_f32_bf16 v207, v127, s6, v207
    v_add_f32_dpp v192, v192, v192 row_ror:8 row_mask:0xf bank_mask:0xf
    v_add_f32_dpp v193, v193, v193 row_ror:8 row_mask:0xf bank_mask:0xf
    v_add_f32_dpp v194, v194, v194 row_ror:8 row_mask:0xf bank_mask:0xf
    v_add_f32_dpp v195, v195, v195 row_ror:8 row_mask:0xf bank_mask:0xf
    v_add_f32_dpp v196, v196, v196 row_ror:8 row_mask:0xf bank_mask:0xf
    v_add_f32_dpp v197, v197, v197 row_ror:8 row_mask:0xf bank_mask:0xf
    v_add_f32_dpp v198, v198, v198 row_ror:8 row_mask:0xf bank_mask:0xf
    v_add_f32_dpp v199, v199, v199 row_ror:8 row_mask:0xf bank_mask:0xf
    v_add_f32_dpp v200, v200, v200 row_ror:8 row_mask:0xf bank_mask:0xf
    v_add_f32_dpp v201, v201, v201 row_ror:8 row_mask:0xf bank_mask:0xf
    v_add_f32_dpp v202, v202, v202 row_ror:8 row_mask:0xf bank_mask:0xf
    v_add_f32_dpp v203, v203, v203 row_ror:8 row_mask:0xf bank_mask:0xf
    v_add_f32_dpp v204, v204, v204 row_ror:8 row_mask:0xf bank_mask:0xf
    v_add_f32_dpp v205, v205, v205 row_ror:8 row_mask:0xf bank_mask:0xf
    v_add_f32_dpp v206, v206, v206 row_ror:8 row_mask:0xf bank_mask:0xf
    v_add_f32_dpp v207, v207, v207 row_ror:8 row_mask:0xf bank_mask:0xf
    s_lshl_b32 s85, s7, 10
    v_lshlrev_b32 v12, 8, v9
    v_lshlrev_b32 v13, 5, v5
    v_add_u32 v12, v12, v13
    v_add_u32 v12, s85, v12
    v_and_b32 v13, 8, v0
    v_cmp_eq_u32 vcc, 0, v13
    s_nop 0
    s_and_saveexec_b64 s[96:97], vcc
    ds_write_b128 v12, v[192:195]
    ds_write_b128 v12, v[196:199] offset:16
    ds_write_b128 v12, v[200:203] offset:4096
    ds_write_b128 v12, v[204:207] offset:4112
    s_mov_b64 exec, s[96:97]
    s_waitcnt lgkmcnt(0)
    s_barrier
    s_cmp_ge_u32 s76, 6
    s_cbranch_scc1 L_hfin
    s_lshl_b32 s85, s7, 12
    v_lshlrev_b32 v12, 2, v0
    v_add_u32 v13, s85, v12
    ds_read_b32 v16, v13 offset:0
    ds_read_b32 v17, v13 offset:256
    ds_read_b32 v18, v13 offset:512
    ds_read_b32 v19, v13 offset:768
    ds_read_b32 v20, v13 offset:1024
    ds_read_b32 v21, v13 offset:1280
    ds_read_b32 v22, v13 offset:1536
    ds_read_b32 v23, v13 offset:1792
    ds_read_b32 v24, v13 offset:2048
    ds_read_b32 v25, v13 offset:2304
    ds_read_b32 v26, v13 offset:2560
    ds_read_b32 v27, v13 offset:2816
    s_waitcnt lgkmcnt(4)
    ds_read_b32 v28, v13 offset:3072
    ds_read_b32 v29, v13 offset:3328
    ds_read_b32 v30, v13 offset:3584
    ds_read_b32 v31, v13 offset:3840
    s_waitcnt lgkmcnt(0)
    v_add_f32 v16, v16, v24
    v_add_f32 v17, v17, v25
    v_add_f32 v18, v18, v26
    v_add_f32 v19, v19, v27
    v_add_f32 v20, v20, v28
    v_add_f32 v21, v21, v29
    v_add_f32 v22, v22, v30
    v_add_f32 v23, v23, v31
    v_add_f32 v16, v16, v20
    v_add_f32 v17, v17, v21
    v_add_f32 v18, v18, v22
    v_add_f32 v19, v19, v23
    v_add_f32 v16, v16, v17
    v_add_f32 v18, v18, v19
    v_add_f32 v16, v16, v18
    s_lshr_b32 s85, s2, 1
    s_lshl_b32 s85, s85, 10
    s_lshl_b32 s86, s7, 9
    s_add_u32 s85, s85, s86
    s_and_b32 s86, s2, 1
    s_lshl_b32 s86, s86, 8
    s_add_u32 s85, s85, s86
    s_add_u32 s85, s85, 262144
    buffer_store_dword v16, v12, s[64:67], s85 offen sc1
    s_waitcnt vmcnt(0)
    s_add_u32 s82, s82, 1
    s_lshl_b32 s85, s2, 7
    s_lshl_b32 s86, s7, 3
    s_add_u32 s85, s85, s86
    s_add_u32 s85, s85, 4096
    v_mov_b32 v12, 0
    v_mov_b32 v10, s82
    v_mov_b32 v11, s83
    s_mov_b64 s[96:97], exec
    s_mov_b64 exec, 1
    buffer_store_dwordx2 v[10:11], v12, s[64:67], s85 offen sc1
    s_mov_b64 exec, s[96:97]
    s_branch L_hfin
L_hupd:
    s_cmp_lg_u32 s2, 28
    s_cbranch_scc1 L_end
    s_cmp_lg_u32 s76, 4
    s_cbranch_scc1 L_end
    s_waitcnt lgkmcnt(0)
    s_add_u32 s82, s82, 1
    v_mul_u32_u24 v11, 37, v0
    v_lshrrev_b32 v11, 8, v11
    v_mul_u32_u24 v12, 7, v11
    v_sub_u32 v12, v0, v12
    v_mul_u32_u24 v11, 3584, v11
    v_lshlrev_b32 v12, 4, v12
    v_add_u32 v11, v11, v12
    v_cmp_gt_u32 vcc, 56, v0
    s_nop 1
    v_cndmask_b32 v11, 0, v11, vcc
    s_mov_b32 s85, 16384
    s_mov_b32 s86, 18176
    s_mov_b32 s94, 0
L_ep_poll:
    s_sleep 64
    buffer_load_dwordx4 v[16:19], v11, s[64:67], s85 offen sc1
    buffer_load_dwordx4 v[20:23], v11, s[64:67], s86 offen sc1
    s_waitcnt vmcnt(0)
    v_xor_b32 v16, s82, v16
    v_xor_b32 v17, s83, v17
    v_xor_b32 v18, s82, v18
    v_xor_b32 v19, s83, v19
    v_xor_b32 v20, s82, v20
    v_xor_b32 v21, s83, v21
    v_xor_b32 v22, s82, v22
    v_xor_b32 v23, s83, v23
    v_or_b32 v26, v16, v17
    v_or3_b32 v26, v26, v18, v19
    v_or3_b32 v26, v26, v20, v21
    v_or3_b32 v26, v26, v22, v23
    v_cmp_ne_u32 vcc, 0, v26
    s_cbranch_vccz L_epoch_store
    s_add_u32 s94, s94, 1
    s_cmp_lt_u32 s94, 20000
    s_cbranch_scc1 L_ep_poll
L_epoch_store:
    v_mov_b32 v8, s82
    v_mov_b32 v9, s83
    v_mov_b32 v10, 0
    s_mov_b64 exec, 1
    buffer_store_dwordx2 v[8:9], v10, s[64:67], 0 offen sc1
    s_branch L_end
L_hfin:
L_end:
    s_endpgm
.section .rodata,"a"
.p2align 6
.amdhsa_kernel recurrent_scan__ssm_conv_s5__glu_gated_glu__prompt_kernel
  .amdhsa_next_free_vgpr 256
  .amdhsa_next_free_sgpr 102
  .amdhsa_accum_offset 256
  .amdhsa_group_segment_fixed_size 0
  .amdhsa_kernarg_size 128
  .amdhsa_user_sgpr_count 2
  .amdhsa_user_sgpr_kernarg_segment_ptr 1
  .amdhsa_system_sgpr_workgroup_id_x 1
.end_amdhsa_kernel
```
